```python
import torch

def _softmax(x, axis=-1):
    return torch.softmax(x, dim=axis)
def _gelu(x):
    return torch.nn.functional.gelu(x, approximate="tanh")
def _silu(x):
    return torch.nn.functional.silu(x)
def _sigmoid(x):
    return torch.sigmoid(x)
def _layernorm(x, axis=-1, eps=1e-5):
    m = x.mean(dim=axis, keepdim=True)
    v = x.var(dim=axis, keepdim=True, unbiased=False)
    return (x - m) / torch.sqrt(v + eps)
def _scatter_add(tgt, idx, src, axis=0):
    return tgt.clone().index_add_(axis, idx, src)
def _segment_sum(src, seg, n):
    out = torch.zeros((n,) + src.shape[1:], dtype=src.dtype)
    return out.index_add_(0, seg, src)
def _pad(x, pw):
    flat = tuple(v for pair in reversed(pw) for v in pair)
    return torch.nn.functional.pad(x, flat)

kernel_name = 'sequential_preLN__sliding_block_cached__glu_gated_glu__decode'

def setup_inputs():

    _w = (lambda a: (lambda t: t.to(torch.bfloat16) if t.is_floating_point() else t)(torch.as_tensor(a)))
    def _A_setup():
        B, Sq, D = 1, 1, 640
        Hq, Hkv, Sk, Dh = 32, 32, 8192, 192
        assert Hq % Hkv == 0, (Hq, Hkv)
        return {
            "x": _w((lambda *s: torch.randn(*s, dtype=torch.bfloat16) * 0.05)(B, Sq, D)),
            "k_cache": _w((lambda *s: torch.randn(*s, dtype=torch.bfloat16) * 3.2)(B, Hkv, Sk, Dh)),
            "v_cache": _w((lambda *s: torch.randn(*s, dtype=torch.bfloat16) * 0.4)(B, Hkv, Sk, Dh)),
            "wq": _w((lambda *s: torch.randn(*s, dtype=torch.bfloat16) * 3.2)(D, Hq * Dh) * (D ** -0.5)),
            "wo": _w((lambda *s: torch.randn(*s, dtype=torch.bfloat16) * 0.4)(Hq * Dh, D) * ((Hq * Dh) ** -0.5)),
        }
    _A_in = _A_setup()

    def _B_setup():
        B, S, D, F = 1, 1, 640, 1536
        return {
            "x": _w((lambda *s: torch.randn(*s, dtype=torch.bfloat16) * 0.05)(B, S, D)),
            "w_gate": _w((lambda *s: torch.randn(*s, dtype=torch.bfloat16) * 0.05)(D, F)),
            "w_up": _w((lambda *s: torch.randn(*s, dtype=torch.bfloat16) * 0.05)(D, F)),
            "w_down": _w((lambda *s: torch.randn(*s, dtype=torch.bfloat16) * 0.05)(F, D)),
        }
    _B_in = _B_setup()

    return {
        "A_x": _A_in["x"],
        "A_k_cache": _A_in["k_cache"],
        "A_v_cache": _A_in["v_cache"],
        "A_wq": _A_in["wq"],
        "A_wo": _A_in["wo"],
        "B_x": _B_in["x"],
        "B_w_gate": _B_in["w_gate"],
        "B_w_up": _B_in["w_up"],
        "B_w_down": _B_in["w_down"],
    }

def reference(A_x, A_k_cache, A_v_cache, A_wq, A_wo, B_x, B_w_gate, B_w_up, B_w_down):
    def _A_ref(x, k_cache, v_cache, wq, wo):
        B, Sq, D = x.shape
        Hq, Dh = 32, 192
        Hkv, Sk = k_cache.shape[1], k_cache.shape[2]
        W = min(4096, max(256, Sk // 4))
        rep = Hq // Hkv
        q = (lambda x, *d: x.permute(*d))((x @ wq).reshape(B, Sq, Hq, Dh), 0, 2, 1, 3)
        k = (lambda x, n, axis: torch.repeat_interleave(x, n, dim=axis))(k_cache[:, :, Sk - W:, :], rep, axis=1)
        v = (lambda x, n, axis: torch.repeat_interleave(x, n, dim=axis))(v_cache[:, :, Sk - W:, :], rep, axis=1)
        scores = torch.einsum("bhqd,bhkd->bhqk", q, k) * (Dh ** -0.5)
        p = _softmax(scores, axis=-1)
        o = torch.einsum("bhqk,bhkd->bhqd", p, v)
        return (lambda x, *d: x.permute(*d))(o, 0, 2, 1, 3).reshape(B, Sq, Hq * Dh) @ wo

    def _B_ref(x, w_gate, w_up, w_down):
        g = torch.einsum("bsd,df->bsf", x, w_gate)
        u = torch.einsum("bsd,df->bsf", x, w_up)
        h = _sigmoid(g) * u
        return torch.einsum("bsf,fd->bsd", h, w_down)

    x = A_x
    h = x + _A_ref(_layernorm(x, axis=-1), A_k_cache, A_v_cache, A_wq, A_wo)
    h2 = h + _B_ref(_layernorm(h, axis=-1), B_w_gate, B_w_up, B_w_down)
    return h2
```

```asm
; @launch grid=(256,1,1) block=(512,1,1) lds=65536
.amdgcn_target "amdgcn-amd-amdhsa--gfx950"
.text
.globl sequential_preLN__sliding_block_cached__glu_gated_glu__decode_kernel
.p2align 8
.type sequential_preLN__sliding_block_cached__glu_gated_glu__decode_kernel,@function
sequential_preLN__sliding_block_cached__glu_gated_glu__decode_kernel:
    s_getpc_b64 s[62:63]
    s_load_dwordx16 s[4:19], s[0:1], 0
    s_load_dwordx8 s[20:27], s[0:1], 64
    s_cmp_ge_u32 s2, 256
    s_cbranch_scc1 L_end
    v_lshlrev_b32 v5, 4, v0
    s_and_b32 s62, s62, 0xffffff00
    v_lshrrev_b32 v4, 6, v0
    v_add_u32 v6, 8192, v5
    v_min_u32 v6, CODE_BYTES-16, v6
    global_load_dwordx4 v[48:51], v5, s[62:63]
    global_load_dwordx4 v[52:55], v6, s[62:63]
    v_and_b32 v0, 63, v0
    v_readfirstlane_b32 s3, v4
    v_lshrrev_b32 v1, 3, v0
    v_and_b32 v2, 7, v0
    s_and_b32 s48, s2, 7
    s_lshr_b32 s49, s2, 3
    s_lshr_b32 s50, s49, 3
    s_and_b32 s51, s49, 7
    s_lshl_b32 s52, s48, 2
    s_add_u32 s52, s52, s50
    s_mul_i32 s63, s51, 80
    s_mul_i32 s54, s63, 12288
    s_mul_i32 s64, s52, 384
    s_add_u32 s54, s54, s64
    s_mov_b32 s60, s3
    s_mul_i32 s64, s60, 171
    s_lshr_b32 s64, s64, 9
    s_mul_i32 s68, s64, 3
    s_sub_u32 s68, s60, s68
    s_mul_i32 s56, s64, 196608
    s_add_u32 s56, s56, s54
    s_lshl_b32 s69, s68, 7
    s_add_u32 s56, s56, s69
    s_lshl_b32 s58, s64, 9
    s_mul_i32 s69, s68, 3072
    s_add_u32 s58, s58, s69
    s_lshl_b32 s60, s64, 5
    s_add_u32 s61, s3, 8
    s_min_u32 s61, s61, 14
    s_mul_i32 s64, s61, 171
    s_lshr_b32 s64, s64, 9
    s_mul_i32 s68, s64, 3
    s_sub_u32 s68, s61, s68
    s_mul_i32 s57, s64, 196608
    s_add_u32 s57, s57, s54
    s_lshl_b32 s69, s68, 7
    s_add_u32 s57, s57, s69
    s_lshl_b32 s59, s64, 9
    s_mul_i32 s69, s68, 3072
    s_add_u32 s59, s59, s69
    s_lshl_b32 s61, s64, 5
    v_mul_u32_u24 v10, 24576, v1
    v_lshl_add_u32 v10, v2, 4, v10
    v_mul_u32_u24 v9, 20, v0
    s_lshl_b32 s63, s63, 1
    v_lshl_add_u32 v14, v1, 2, s63
    v_add_u32 v7, s60, v14
    v_add_u32 v8, s61, v14
    s_mul_i32 s65, s48, 173184
    s_mul_i32 s47, s49, 5248
    s_add_u32 s65, s65, s47
    s_waitcnt lgkmcnt(0)
    s_mov_b32 s36, s10
    s_mov_b32 s37, s11
    s_mov_b32 s38, 7864320
    s_mov_b32 s39, 0x20000
    global_load_dwordx4 v[40:43], v9, s[4:5]
    global_load_dword v44, v9, s[4:5] offset:16
    global_load_dword v45, v7, s[4:5]
    global_load_dword v46, v8, s[4:5]
    s_add_u32 s64, s56, 12288
    buffer_load_dwordx4 v[160:163], v10, s[36:39], s56 offen nt
    buffer_load_dwordx4 v[164:167], v10, s[36:39], s64 offen nt
    s_cmp_eq_u32 s3, 7
    s_cbranch_scc1 L_w7
    s_add_u32 s64, s57, 12288
    buffer_load_dwordx4 v[168:171], v10, s[36:39], s57 offen nt
    buffer_load_dwordx4 v[172:175], v10, s[36:39], s64 offen nt
    s_branch L_w7_done
L_w7:
    v_lshlrev_b32 v13, 4, v0
    v_mov_b32 v64, -1
    v_mov_b32 v65, -1
    v_mov_b32 v66, -1
    v_mov_b32 v67, -1
    s_add_u32 s64, s65, 4096
    v_add_u32 v5, s64, v13
    global_store_dwordx4 v5, v[64:67], s[26:27] offset:0 sc1
    global_store_dwordx4 v5, v[64:67], s[26:27] offset:1024 sc1
    global_store_dwordx4 v5, v[64:67], s[26:27] offset:2048 sc1
    global_store_dwordx4 v5, v[64:67], s[26:27] offset:3072 sc1
    s_cmp_lt_u32 s2, 160
    s_cbranch_scc1 L_clr2
    v_add_u32 v5, 4096, v5
    global_store_dwordx4 v5, v[64:67], s[26:27] sc1
L_clr2:
    v_mov_b32 v68, 0
    v_mov_b32 v69, 0
    v_lshlrev_b32 v6, 3, v0
    ds_write_b64 v6, v[68:69] offset:8192
    ds_write_b64 v6, v[68:69] offset:11264
    ds_write_b64 v6, v[68:69] offset:14336
L_w7_done:
    s_load_dword s67, s[26:27], 0
    s_add_u32 s26, s26, 4096
    s_addc_u32 s27, s27, 0
    s_mov_b32 s28, s6
    s_mov_b32 s29, s7
    s_mov_b32 s30, 100663296
    s_mov_b32 s31, 0x20000
    s_mov_b32 s32, s8
    s_mov_b32 s33, s9
    s_mov_b32 s34, 100663296
    s_mov_b32 s35, 0x20000
    s_mul_i32 s53, s52, 3145728
    s_mul_i32 s60, s51, 98304
    s_add_u32 s53, s53, s60
    s_mul_i32 s60, s3, 24576
    s_add_u32 s53, s53, s60
    s_add_u32 s53, s53, 2359296
    v_mul_u32_u24 v3, 384, v1
    v_lshl_add_u32 v3, v2, 4, v3
    s_barrier
    s_cmp_ge_u32 s3, 4
    s_cbranch_scc1 L_nok0
    buffer_load_dwordx4 v[64:67], v3, s[28:31], s53 offen offset:0 nt
    buffer_load_dwordx4 v[68:71], v3, s[28:31], s53 offen offset:128 nt
    buffer_load_dwordx4 v[72:75], v3, s[28:31], s53 offen offset:256 nt
L_nok0:
    v_lshlrev_b32 v4, 2, v0
    v_mov_b32 v23, 0
    v_and_b32 v13, 1, v2
    v_lshlrev_b32 v13, 4, v13
    v_mov_b32 v14, 0xffff
    v_lshlrev_b32 v14, v13, v14
    v_lshrrev_b32 v13, 1, v2
    v_cmp_eq_u32 vcc, 0, v13
    s_nop 1
    v_cndmask_b32 v16, 0, v14, vcc
    v_cmp_eq_u32 vcc, 1, v13
    s_nop 1
    v_cndmask_b32 v17, 0, v14, vcc
    v_cmp_eq_u32 vcc, 2, v13
    s_nop 1
    v_cndmask_b32 v18, 0, v14, vcc
    v_cmp_eq_u32 vcc, 3, v13
    s_nop 1
    v_cndmask_b32 v19, 0, v14, vcc
    v_bfe_u32 v13, v0, 4, 1
    v_lshlrev_b32 v13, 4, v13
    v_lshl_add_u32 v15, v2, 5, v13
    s_mov_b32 s98, 0x00ff00ff
    s_mov_b32 s99, 0xff00ff00
    v_lshlrev_b32 v21, 4, v0
    v_lshrrev_b32 v13, 5, v0
    v_lshl_add_u32 v22, v13, 8, v15
    v_and_b32 v20, 15, v0
    v_lshl_add_u32 v20, v20, 2, v13
    v_bfe_u32 v13, v0, 4, 1
    v_lshl_add_u32 v20, v13, 1, v20
    v_lshlrev_b32 v20, 2, v20
    s_mul_i32 s66, s50, 41984
    s_mul_i32 s47, s48, 173184
    s_add_u32 s66, s66, s47
    v_add_u32 v24, s58, v22
    v_add_u32 v25, s59, v22
    v_bfe_u32 v13, v20, 2, 4
    v_lshrrev_b32 v14, 7, v20
    v_lshl_add_u32 v26, v13, 2, v14
    v_bfe_u32 v13, v20, 6, 1
    v_lshl_add_u32 v26, v13, 1, v26
    v_lshlrev_b32 v26, 2, v26
    s_cmp_ge_u32 s3, 4
    s_cbranch_scc1 L_xw_h
    s_waitcnt vmcnt(7)
    s_branch L_xw_d
L_xw_h:
    s_waitcnt vmcnt(4)
L_xw_d:
    v_lshlrev_b32 v48, 16, v40
    v_and_b32 v49, 0xffff0000, v40
    v_lshlrev_b32 v50, 16, v41
    v_and_b32 v51, 0xffff0000, v41
    v_lshlrev_b32 v52, 16, v42
    v_and_b32 v53, 0xffff0000, v42
    v_lshlrev_b32 v54, 16, v43
    v_and_b32 v55, 0xffff0000, v43
    v_lshlrev_b32 v56, 16, v44
    v_and_b32 v57, 0xffff0000, v44
    v_lshlrev_b32 v9, 16, v45
    v_and_b32 v10, 0xffff0000, v45
    v_lshlrev_b32 v11, 16, v46
    v_and_b32 v12, 0xffff0000, v46
    v_add_f32 v7, v48, v49
    v_add_f32 v8, v50, v51
    v_add_f32 v7, v7, v52
    v_add_f32 v8, v8, v53
    v_add_f32 v7, v7, v54
    v_add_f32 v8, v8, v55
    v_add_f32 v7, v7, v56
    v_add_f32 v8, v8, v57
    v_add_f32 v7, v7, v8
    v_mov_b32 v5, 0x3acccccd
    s_nop 0
    v_add_f32_dpp v7, v7, v7 quad_perm:[1,0,3,2] row_mask:0xf bank_mask:0xf
    s_nop 1
    v_add_f32_dpp v7, v7, v7 quad_perm:[2,3,0,1] row_mask:0xf bank_mask:0xf
    s_nop 1
    v_add_f32_dpp v7, v7, v7 row_half_mirror row_mask:0xf bank_mask:0xf
    s_nop 1
    v_add_f32_dpp v7, v7, v7 row_ror:8 row_mask:0xf bank_mask:0xf
    s_nop 1
    v_add_f32_dpp v7, v7, v7 row_bcast:15 row_mask:0xa bank_mask:0xf
    s_nop 1
    v_add_f32_dpp v7, v7, v7 row_bcast:31 row_mask:0xc bank_mask:0xf
    s_nop 0
    v_readlane_b32 s60, v7, 63
    s_nop 1
    v_mul_f32 v5, s60, v5
    v_sub_f32 v48, v48, v5
    v_sub_f32 v49, v49, v5
    v_sub_f32 v50, v50, v5
    v_sub_f32 v51, v51, v5
    v_sub_f32 v52, v52, v5
    v_sub_f32 v53, v53, v5
    v_sub_f32 v54, v54, v5
    v_sub_f32 v55, v55, v5
    v_sub_f32 v56, v56, v5
    v_sub_f32 v57, v57, v5
    v_mul_f32 v7, v48, v48
    v_mul_f32 v8, v49, v49
    v_fmac_f32 v7, v50, v50
    v_fmac_f32 v8, v51, v51
    v_fmac_f32 v7, v52, v52
    v_fmac_f32 v8, v53, v53
    v_fmac_f32 v7, v54, v54
    v_fmac_f32 v8, v55, v55
    v_fmac_f32 v7, v56, v56
    v_fmac_f32 v8, v57, v57
    v_add_f32 v7, v7, v8
    v_mov_b32 v8, 0x3acccccd
    v_cvt_pk_bf16_f32 v5, v5, v5
    v_and_b32 v5, 0xffff0000, v5
    v_add_f32_dpp v7, v7, v7 quad_perm:[1,0,3,2] row_mask:0xf bank_mask:0xf
    s_nop 1
    v_add_f32_dpp v7, v7, v7 quad_perm:[2,3,0,1] row_mask:0xf bank_mask:0xf
    s_nop 1
    v_add_f32_dpp v7, v7, v7 row_half_mirror row_mask:0xf bank_mask:0xf
    s_nop 1
    v_add_f32_dpp v7, v7, v7 row_ror:8 row_mask:0xf bank_mask:0xf
    s_nop 1
    v_add_f32_dpp v7, v7, v7 row_bcast:15 row_mask:0xa bank_mask:0xf
    s_nop 1
    v_add_f32_dpp v7, v7, v7 row_bcast:31 row_mask:0xc bank_mask:0xf
    s_nop 0
    v_readlane_b32 s60, v7, 63
    s_nop 1
    v_mul_f32 v7, s60, v8
    v_cvt_pk_bf16_f32 v7, v7, v7
    v_and_b32 v7, 0xffff0000, v7
    v_add_f32 v7, 0x3727c5ac, v7
    v_cvt_pk_bf16_f32 v7, v7, v7
    v_and_b32 v7, 0xffff0000, v7
    v_sqrt_f32 v7, v7
    s_nop 0
    v_cvt_pk_bf16_f32 v7, v7, v7
    v_and_b32 v7, 0xffff0000, v7
    v_rcp_f32 v6, v7
    v_sub_f32 v9, v9, v5
    v_sub_f32 v10, v10, v5
    v_sub_f32 v11, v11, v5
    v_sub_f32 v12, v12, v5
    v_cvt_pk_bf16_f32 v9, v9, v9
    v_and_b32 v9, 0xffff0000, v9
    v_cvt_pk_bf16_f32 v10, v10, v10
    v_and_b32 v10, 0xffff0000, v10
    v_cvt_pk_bf16_f32 v11, v11, v11
    v_and_b32 v11, 0xffff0000, v11
    v_cvt_pk_bf16_f32 v12, v12, v12
    v_and_b32 v12, 0xffff0000, v12
    v_mul_f32 v9, v9, v6
    v_mul_f32 v10, v10, v6
    v_mul_f32 v11, v11, v6
    v_mul_f32 v12, v12, v6
    v_cvt_pk_bf16_f32 v9, v9, v9
    v_cvt_pk_bf16_f32 v10, v10, v10
    v_cvt_pk_bf16_f32 v11, v11, v11
    v_cvt_pk_bf16_f32 v12, v12, v12
    v_and_b32 v28, v9, v16
    v_and_b32 v29, v9, v17
    v_and_b32 v30, v9, v18
    v_and_b32 v31, v9, v19
    v_and_b32 v32, v10, v16
    v_and_b32 v33, v10, v17
    v_and_b32 v34, v10, v18
    v_and_b32 v35, v10, v19
    v_and_b32 v36, v11, v16
    v_and_b32 v37, v11, v17
    v_and_b32 v38, v11, v18
    v_and_b32 v39, v11, v19
    v_and_b32 v40, v12, v16
    v_and_b32 v41, v12, v17
    v_and_b32 v42, v12, v18
    v_and_b32 v43, v12, v19
    s_waitcnt lgkmcnt(0)
    s_add_u32 s67, s67, 1
    s_cmp_ge_u32 s3, 4
    s_cbranch_scc1 L_qw_h
    s_waitcnt vmcnt(3)
    s_add_u32 s64, s53, 3072
    buffer_load_dwordx4 v[76:79], v3, s[28:31], s64 offen offset:0 nt
    s_add_u32 s64, s53, 3072
    buffer_load_dwordx4 v[80:83], v3, s[28:31], s64 offen offset:128 nt
    s_add_u32 s64, s53, 3072
    buffer_load_dwordx4 v[84:87], v3, s[28:31], s64 offen offset:256 nt
    s_branch L_qw_d
L_qw_h:
    s_waitcnt vmcnt(0)
    s_cmp_lg_u32 s3, 7
    s_cbranch_scc1 L_qw_d
    s_getreg_b32 s60, hwreg(HW_REG_XCC_ID)
    v_mov_b32 v5, s65
    v_mov_b32 v6, s67
    v_mov_b32 v7, s60
    s_mov_b64 exec, 1
    global_store_dwordx2 v5, v[6:7], s[26:27] offset:1664 sc1
    s_mov_b64 exec, -1
L_qw_d:
    v_mfma_f32_16x16x32_bf16 v[48:51], v[28:31], v[160:163], 0
    v_mfma_f32_16x16x32_bf16 v[48:51], v[32:35], v[164:167], v[48:51]
    s_cmp_eq_u32 s3, 7
    s_cbranch_scc1 L_q1
    v_mfma_f32_16x16x32_bf16 v[52:55], v[36:39], v[168:171], 0
    v_mfma_f32_16x16x32_bf16 v[52:55], v[40:43], v[172:175], v[52:55]
    s_mov_b64 exec, s[98:99]
    s_nop 6
    ds_write_b128 v25, v[52:55] offset:5632
    s_mov_b64 exec, -1
L_q1:
    s_mov_b64 exec, s[98:99]
    s_nop 4
    ds_write_b128 v24, v[48:51] offset:5632
    s_mov_b64 exec, -1
    s_mov_b32 s36, s4
    s_mov_b32 s37, s5
    s_cmp_ge_u32 s2, 160
    s_cbranch_scc1 L_role_mlp
    s_cmp_ge_u32 s49, 10
    s_cselect_b32 s60, 1, 0
    s_mul_i32 s61, s60, 10
    s_sub_u32 s61, s49, s61
    s_lshl_b32 s62, s48, 2
    s_lshl_b32 s63, s60, 1
    s_add_u32 s62, s62, s63
    s_mul_i32 s62, s62, 192
    s_mul_i32 s63, s3, 48
    s_add_u32 s62, s62, s63
    s_mul_i32 s56, s62, 1280
    s_lshl_b32 s63, s61, 7
    s_add_u32 s56, s56, s63
    s_mov_b32 s40, s12
    s_mov_b32 s41, s13
    s_mov_b32 s42, 7864320
    s_mov_b32 s43, 0x20000
    s_mov_b32 s44, s12
    s_mov_b32 s45, s13
    s_mov_b32 s46, 7864320
    s_mov_b32 s47, 0x20000
    v_mul_u32_u24 v13, 1280, v1
    v_lshl_add_u32 v13, v2, 4, v13
    s_branch L_role_done
L_role_mlp:
    s_mul_i32 s60, s48, 12
    s_add_u32 s60, s60, s49
    s_sub_u32 s60, s60, 20
    s_and_b32 s61, s60, 3
    s_mul_i32 s56, s61, 491520
    s_and_b32 s61, s3, 3
    s_mul_i32 s61, s61, 122880
    s_add_u32 s56, s56, s61
    s_lshr_b32 s61, s60, 2
    s_lshl_b32 s61, s61, 7
    s_add_u32 s56, s56, s61
    s_cmp_ge_u32 s3, 4
    s_cselect_b32 s40, s18, s16
    s_cselect_b32 s41, s19, s17
    s_mov_b32 s42, 1966080
    s_mov_b32 s43, 0x20000
    s_mov_b32 s44, s20
    s_mov_b32 s45, s21
    s_mov_b32 s46, 1966080
    s_mov_b32 s47, 0x20000
    s_mul_i32 s57, s60, 20480
    s_lshl_b32 s61, s3, 8
    s_add_u32 s57, s57, s61
    v_mul_u32_u24 v13, 3072, v1
    v_lshl_add_u32 v13, v2, 4, v13
L_role_done:
    s_waitcnt lgkmcnt(0)
    s_barrier
    s_cmp_ge_u32 s3, 4
    s_cbranch_scc1 L_helper
    s_waitcnt vmcnt(5)
    s_add_u32 s64, s53, 6144
    buffer_load_dwordx4 v[88:91], v3, s[28:31], s64 offen offset:0 nt
    s_waitcnt vmcnt(5)
    s_add_u32 s64, s53, 6144
    buffer_load_dwordx4 v[92:95], v3, s[28:31], s64 offen offset:128 nt
    s_waitcnt vmcnt(5)
    s_add_u32 s64, s53, 6144
    buffer_load_dwordx4 v[96:99], v3, s[28:31], s64 offen offset:256 nt
    s_waitcnt vmcnt(5)
    s_add_u32 s64, s53, 9216
    buffer_load_dwordx4 v[100:103], v3, s[28:31], s64 offen offset:0 nt
    s_waitcnt vmcnt(5)
    s_add_u32 s64, s53, 9216
    buffer_load_dwordx4 v[104:107], v3, s[28:31], s64 offen offset:128 nt
    s_waitcnt vmcnt(5)
    s_add_u32 s64, s53, 9216
    buffer_load_dwordx4 v[108:111], v3, s[28:31], s64 offen offset:256 nt
    s_waitcnt vmcnt(5)
    s_add_u32 s64, s53, 12288
    buffer_load_dwordx4 v[112:115], v3, s[28:31], s64 offen offset:0 nt
    s_waitcnt vmcnt(5)
    s_add_u32 s64, s53, 12288
    buffer_load_dwordx4 v[116:119], v3, s[28:31], s64 offen offset:128 nt
    s_waitcnt vmcnt(5)
    s_add_u32 s64, s53, 12288
    buffer_load_dwordx4 v[120:123], v3, s[28:31], s64 offen offset:256 nt
    s_waitcnt vmcnt(5)
    s_add_u32 s64, s53, 15360
    buffer_load_dwordx4 v[124:127], v3, s[28:31], s64 offen offset:0 nt
    s_waitcnt vmcnt(5)
    s_add_u32 s64, s53, 15360
    buffer_load_dwordx4 v[128:131], v3, s[28:31], s64 offen offset:128 nt
    s_waitcnt vmcnt(5)
    s_add_u32 s64, s53, 15360
    buffer_load_dwordx4 v[132:135], v3, s[28:31], s64 offen offset:256 nt
    s_waitcnt vmcnt(5)
    s_add_u32 s64, s53, 18432
    buffer_load_dwordx4 v[136:139], v3, s[28:31], s64 offen offset:0 nt
    s_waitcnt vmcnt(5)
    s_add_u32 s64, s53, 18432
    buffer_load_dwordx4 v[140:143], v3, s[28:31], s64 offen offset:128 nt
    s_waitcnt vmcnt(5)
    s_add_u32 s64, s53, 18432
    buffer_load_dwordx4 v[144:147], v3, s[28:31], s64 offen offset:256 nt
    s_waitcnt vmcnt(5)
    s_add_u32 s64, s53, 21504
    buffer_load_dwordx4 v[148:151], v3, s[28:31], s64 offen offset:0 nt
    s_waitcnt vmcnt(5)
    s_add_u32 s64, s53, 21504
    buffer_load_dwordx4 v[152:155], v3, s[28:31], s64 offen offset:128 nt
    s_waitcnt vmcnt(5)
    s_add_u32 s64, s53, 21504
    buffer_load_dwordx4 v[156:159], v3, s[28:31], s64 offen offset:256 nt
    s_waitcnt vmcnt(5)
    buffer_load_dwordx4 v[160:163], v3, s[32:35], s53 offen offset:0 nt
    s_waitcnt vmcnt(5)
    buffer_load_dwordx4 v[164:167], v3, s[32:35], s53 offen offset:128 nt
    s_waitcnt vmcnt(5)
    buffer_load_dwordx4 v[168:171], v3, s[32:35], s53 offen offset:256 nt
    s_waitcnt vmcnt(5)
    s_add_u32 s64, s53, 3072
    buffer_load_dwordx4 v[172:175], v3, s[32:35], s64 offen offset:0 nt
    s_waitcnt vmcnt(5)
    s_add_u32 s64, s53, 3072
    buffer_load_dwordx4 v[176:179], v3, s[32:35], s64 offen offset:128 nt
    s_waitcnt vmcnt(5)
    s_add_u32 s64, s53, 3072
    buffer_load_dwordx4 v[180:183], v3, s[32:35], s64 offen offset:256 nt
    s_barrier
    v_lshlrev_b32 v5, 4, v2
    ds_read_b128 v[28:31], v5 offset:1024
    ds_read_b128 v[32:35], v5 offset:1152
    ds_read_b128 v[36:39], v5 offset:1280
    s_waitcnt lgkmcnt(0)
    v_dot2_f32_bf16 v40, v64, v28, 0
    v_dot2_f32_bf16 v41, v76, v28, 0
    v_dot2_f32_bf16 v40, v65, v29, v40
    v_dot2_f32_bf16 v41, v77, v29, v41
    v_dot2_f32_bf16 v40, v66, v30, v40
    v_dot2_f32_bf16 v41, v78, v30, v41
    v_dot2_f32_bf16 v40, v67, v31, v40
    v_dot2_f32_bf16 v41, v79, v31, v41
    v_dot2_f32_bf16 v40, v68, v32, v40
    v_dot2_f32_bf16 v41, v80, v32, v41
    v_dot2_f32_bf16 v40, v69, v33, v40
    v_dot2_f32_bf16 v41, v81, v33, v41
    v_dot2_f32_bf16 v40, v70, v34, v40
    v_dot2_f32_bf16 v41, v82, v34, v41
    v_dot2_f32_bf16 v40, v71, v35, v40
    v_dot2_f32_bf16 v41, v83, v35, v41
    v_dot2_f32_bf16 v40, v72, v36, v40
    v_dot2_f32_bf16 v41, v84, v36, v41
    v_dot2_f32_bf16 v40, v73, v37, v40
    v_dot2_f32_bf16 v41, v85, v37, v41
    v_dot2_f32_bf16 v40, v74, v38, v40
    v_dot2_f32_bf16 v41, v86, v38, v41
    v_dot2_f32_bf16 v40, v75, v39, v40
    v_dot2_f32_bf16 v41, v87, v39, v41
    s_waitcnt vmcnt(5)
    s_add_u32 s64, s53, 6144
    buffer_load_dwordx4 v[184:187], v3, s[32:35], s64 offen offset:0 nt
    v_dot2_f32_bf16 v42, v88, v28, 0
    v_dot2_f32_bf16 v43, v100, v28, 0
    v_dot2_f32_bf16 v42, v89, v29, v42
    v_dot2_f32_bf16 v43, v101, v29, v43
    v_dot2_f32_bf16 v42, v90, v30, v42
    v_dot2_f32_bf16 v43, v102, v30, v43
    v_dot2_f32_bf16 v42, v91, v31, v42
    v_dot2_f32_bf16 v43, v103, v31, v43
    v_dot2_f32_bf16 v42, v92, v32, v42
    v_dot2_f32_bf16 v43, v104, v32, v43
    v_dot2_f32_bf16 v42, v93, v33, v42
    v_dot2_f32_bf16 v43, v105, v33, v43
    v_dot2_f32_bf16 v42, v94, v34, v42
    v_dot2_f32_bf16 v43, v106, v34, v43
    v_dot2_f32_bf16 v42, v95, v35, v42
    v_dot2_f32_bf16 v43, v107, v35, v43
    v_dot2_f32_bf16 v42, v96, v36, v42
    v_dot2_f32_bf16 v43, v108, v36, v43
    v_dot2_f32_bf16 v42, v97, v37, v42
    v_dot2_f32_bf16 v43, v109, v37, v43
    v_dot2_f32_bf16 v42, v98, v38, v42
    v_dot2_f32_bf16 v43, v110, v38, v43
    v_dot2_f32_bf16 v42, v99, v39, v42
    v_dot2_f32_bf16 v43, v111, v39, v43
    s_waitcnt vmcnt(5)
    s_add_u32 s64, s53, 6144
    buffer_load_dwordx4 v[188:191], v3, s[32:35], s64 offen offset:128 nt
    v_dot2_f32_bf16 v44, v112, v28, 0
    v_dot2_f32_bf16 v45, v124, v28, 0
    v_dot2_f32_bf16 v44, v113, v29, v44
    v_dot2_f32_bf16 v45, v125, v29, v45
    v_dot2_f32_bf16 v44, v114, v30, v44
    v_dot2_f32_bf16 v45, v126, v30, v45
    v_dot2_f32_bf16 v44, v115, v31, v44
    v_dot2_f32_bf16 v45, v127, v31, v45
    v_dot2_f32_bf16 v44, v116, v32, v44
    v_dot2_f32_bf16 v45, v128, v32, v45
    v_dot2_f32_bf16 v44, v117, v33, v44
    v_dot2_f32_bf16 v45, v129, v33, v45
    v_dot2_f32_bf16 v44, v118, v34, v44
    v_dot2_f32_bf16 v45, v130, v34, v45
    v_dot2_f32_bf16 v44, v119, v35, v44
    v_dot2_f32_bf16 v45, v131, v35, v45
    v_dot2_f32_bf16 v44, v120, v36, v44
    v_dot2_f32_bf16 v45, v132, v36, v45
    v_dot2_f32_bf16 v44, v121, v37, v44
    v_dot2_f32_bf16 v45, v133, v37, v45
    v_dot2_f32_bf16 v44, v122, v38, v44
    v_dot2_f32_bf16 v45, v134, v38, v45
    v_dot2_f32_bf16 v44, v123, v39, v44
    v_dot2_f32_bf16 v45, v135, v39, v45
    s_waitcnt vmcnt(5)
    s_add_u32 s64, s53, 6144
    buffer_load_dwordx4 v[192:195], v3, s[32:35], s64 offen offset:256 nt
    v_dot2_f32_bf16 v46, v136, v28, 0
    v_dot2_f32_bf16 v47, v148, v28, 0
    v_dot2_f32_bf16 v46, v137, v29, v46
    v_dot2_f32_bf16 v47, v149, v29, v47
    v_dot2_f32_bf16 v46, v138, v30, v46
    v_dot2_f32_bf16 v47, v150, v30, v47
    v_dot2_f32_bf16 v46, v139, v31, v46
    v_dot2_f32_bf16 v47, v151, v31, v47
    v_dot2_f32_bf16 v46, v140, v32, v46
    v_dot2_f32_bf16 v47, v152, v32, v47
    v_dot2_f32_bf16 v46, v141, v33, v46
    v_dot2_f32_bf16 v47, v153, v33, v47
    v_dot2_f32_bf16 v46, v142, v34, v46
    v_dot2_f32_bf16 v47, v154, v34, v47
    v_dot2_f32_bf16 v46, v143, v35, v46
    v_dot2_f32_bf16 v47, v155, v35, v47
    v_dot2_f32_bf16 v46, v144, v36, v46
    v_dot2_f32_bf16 v47, v156, v36, v47
    v_dot2_f32_bf16 v46, v145, v37, v46
    v_dot2_f32_bf16 v47, v157, v37, v47
    v_dot2_f32_bf16 v46, v146, v38, v46
    v_dot2_f32_bf16 v47, v158, v38, v47
    v_dot2_f32_bf16 v46, v147, v39, v46
    v_dot2_f32_bf16 v47, v159, v39, v47
    s_waitcnt vmcnt(5)
    s_add_u32 s64, s53, 9216
    buffer_load_dwordx4 v[196:199], v3, s[32:35], s64 offen offset:0 nt
    v_add_f32_dpp v40, v40, v40 quad_perm:[1,0,3,2] row_mask:0xf bank_mask:0xf
    v_add_f32_dpp v41, v41, v41 quad_perm:[1,0,3,2] row_mask:0xf bank_mask:0xf
    v_add_f32_dpp v42, v42, v42 quad_perm:[1,0,3,2] row_mask:0xf bank_mask:0xf
    v_add_f32_dpp v43, v43, v43 quad_perm:[1,0,3,2] row_mask:0xf bank_mask:0xf
    v_add_f32_dpp v44, v44, v44 quad_perm:[1,0,3,2] row_mask:0xf bank_mask:0xf
    v_add_f32_dpp v45, v45, v45 quad_perm:[1,0,3,2] row_mask:0xf bank_mask:0xf
    v_add_f32_dpp v46, v46, v46 quad_perm:[1,0,3,2] row_mask:0xf bank_mask:0xf
    v_add_f32_dpp v47, v47, v47 quad_perm:[1,0,3,2] row_mask:0xf bank_mask:0xf
    v_add_f32_dpp v40, v40, v40 quad_perm:[2,3,0,1] row_mask:0xf bank_mask:0xf
    v_add_f32_dpp v41, v41, v41 quad_perm:[2,3,0,1] row_mask:0xf bank_mask:0xf
    v_add_f32_dpp v42, v42, v42 quad_perm:[2,3,0,1] row_mask:0xf bank_mask:0xf
    v_add_f32_dpp v43, v43, v43 quad_perm:[2,3,0,1] row_mask:0xf bank_mask:0xf
    v_add_f32_dpp v44, v44, v44 quad_perm:[2,3,0,1] row_mask:0xf bank_mask:0xf
    v_add_f32_dpp v45, v45, v45 quad_perm:[2,3,0,1] row_mask:0xf bank_mask:0xf
    v_add_f32_dpp v46, v46, v46 quad_perm:[2,3,0,1] row_mask:0xf bank_mask:0xf
    v_add_f32_dpp v47, v47, v47 quad_perm:[2,3,0,1] row_mask:0xf bank_mask:0xf
    v_add_f32_dpp v40, v40, v40 row_half_mirror row_mask:0xf bank_mask:0xf
    v_add_f32_dpp v41, v41, v41 row_half_mirror row_mask:0xf bank_mask:0xf
    v_add_f32_dpp v42, v42, v42 row_half_mirror row_mask:0xf bank_mask:0xf
    v_add_f32_dpp v43, v43, v43 row_half_mirror row_mask:0xf bank_mask:0xf
    v_add_f32_dpp v44, v44, v44 row_half_mirror row_mask:0xf bank_mask:0xf
    v_add_f32_dpp v45, v45, v45 row_half_mirror row_mask:0xf bank_mask:0xf
    v_add_f32_dpp v46, v46, v46 row_half_mirror row_mask:0xf bank_mask:0xf
    v_add_f32_dpp v47, v47, v47 row_half_mirror row_mask:0xf bank_mask:0xf
    s_waitcnt vmcnt(5)
    s_add_u32 s64, s53, 9216
    buffer_load_dwordx4 v[200:203], v3, s[32:35], s64 offen offset:128 nt
    v_cvt_pk_bf16_f32 v5, v40, v41
    v_cvt_pk_bf16_f32 v6, v42, v43
    v_cvt_pk_bf16_f32 v7, v44, v45
    v_cvt_pk_bf16_f32 v8, v46, v47
    v_lshlrev_b32 v40, 16, v5
    v_and_b32 v41, 0xffff0000, v5
    v_lshlrev_b32 v42, 16, v6
    v_and_b32 v43, 0xffff0000, v6
    v_lshlrev_b32 v44, 16, v7
    v_and_b32 v45, 0xffff0000, v7
    v_lshlrev_b32 v46, 16, v8
    v_and_b32 v47, 0xffff0000, v8
    v_mul_f32 v40, 0x3d93cd3a, v40
    v_mul_f32 v41, 0x3d93cd3a, v41
    v_mul_f32 v42, 0x3d93cd3a, v42
    v_mul_f32 v43, 0x3d93cd3a, v43
    v_mul_f32 v44, 0x3d93cd3a, v44
    v_mul_f32 v45, 0x3d93cd3a, v45
    v_mul_f32 v46, 0x3d93cd3a, v46
    v_mul_f32 v47, 0x3d93cd3a, v47
    v_cvt_pk_bf16_f32 v5, v40, v41
    v_cvt_pk_bf16_f32 v6, v42, v43
    v_cvt_pk_bf16_f32 v7, v44, v45
    v_cvt_pk_bf16_f32 v8, v46, v47
    v_lshlrev_b32 v40, 16, v5
    v_and_b32 v41, 0xffff0000, v5
    v_lshlrev_b32 v42, 16, v6
    v_and_b32 v43, 0xffff0000, v6
    v_lshlrev_b32 v44, 16, v7
    v_and_b32 v45, 0xffff0000, v7
    v_lshlrev_b32 v46, 16, v8
    v_and_b32 v47, 0xffff0000, v8
    v_max3_f32 v5, v40, v41, v42
    v_max3_f32 v6, v43, v44, v45
    v_max3_f32 v5, v5, v46, v47
    v_max_f32 v5, v5, v6
    s_nop 1
    v_max_f32_dpp v5, v5, v5 row_ror:8 row_mask:0xf bank_mask:0xf
    s_nop 1
    v_max_f32_dpp v5, v5, v5 row_bcast:15 row_mask:0xa bank_mask:0xf
    s_nop 1
    v_max_f32_dpp v5, v5, v5 row_bcast:31 row_mask:0xc bank_mask:0xf
    s_nop 0
    v_readlane_b32 s60, v5, 63
    s_nop 1
    v_subrev_f32 v48, s60, v40
    v_subrev_f32 v49, s60, v41
    v_subrev_f32 v50, s60, v42
    v_subrev_f32 v51, s60, v43
    v_subrev_f32 v52, s60, v44
    v_subrev_f32 v53, s60, v45
    v_subrev_f32 v54, s60, v46
    v_subrev_f32 v55, s60, v47
    v_mul_f32 v48, 0x3fb8aa3b, v48
    v_mul_f32 v49, 0x3fb8aa3b, v49
    v_mul_f32 v50, 0x3fb8aa3b, v50
    v_mul_f32 v51, 0x3fb8aa3b, v51
    v_mul_f32 v52, 0x3fb8aa3b, v52
    v_mul_f32 v53, 0x3fb8aa3b, v53
    v_mul_f32 v54, 0x3fb8aa3b, v54
    v_mul_f32 v55, 0x3fb8aa3b, v55
    v_exp_f32 v48, v48
    v_exp_f32 v49, v49
    v_exp_f32 v50, v50
    v_exp_f32 v51, v51
    v_exp_f32 v52, v52
    v_exp_f32 v53, v53
    v_exp_f32 v54, v54
    v_exp_f32 v55, v55
    v_add_f32 v48, v48, v52
    v_add_f32 v49, v49, v53
    v_add_f32 v50, v50, v54
    v_add_f32 v51, v51, v55
    v_add_f32 v48, v48, v49
    v_add_f32 v50, v50, v51
    v_add_f32 v5, v48, v50
    s_nop 1
    v_add_f32_dpp v5, v5, v5 row_ror:8 row_mask:0xf bank_mask:0xf
    s_nop 1
    v_add_f32_dpp v5, v5, v5 row_bcast:15 row_mask:0xa bank_mask:0xf
    s_nop 1
    v_add_f32_dpp v5, v5, v5 row_bcast:31 row_mask:0xc bank_mask:0xf
    s_nop 0
    v_readlane_b32 s61, v5, 63
    v_mov_b32 v6, s60
    s_nop 0
    v_mov_b32 v7, s61
    s_lshl_b32 s62, s3, 3
    v_mov_b32 v5, s62
    ds_write_b64 v5, v[6:7] offset:1408
    s_waitcnt lgkmcnt(0)
    s_barrier
    s_waitcnt vmcnt(5)
    s_add_u32 s64, s53, 9216
    buffer_load_dwordx4 v[204:207], v3, s[32:35], s64 offen offset:256 nt
    s_waitcnt vmcnt(5)
    s_add_u32 s64, s53, 12288
    buffer_load_dwordx4 v[208:211], v3, s[32:35], s64 offen offset:0 nt
    s_waitcnt vmcnt(5)
    s_add_u32 s64, s53, 12288
    buffer_load_dwordx4 v[212:215], v3, s[32:35], s64 offen offset:128 nt
    s_waitcnt vmcnt(5)
    s_add_u32 s64, s53, 12288
    buffer_load_dwordx4 v[216:219], v3, s[32:35], s64 offen offset:256 nt
    s_waitcnt vmcnt(5)
    s_add_u32 s64, s53, 15360
    buffer_load_dwordx4 v[220:223], v3, s[32:35], s64 offen offset:0 nt
    s_waitcnt vmcnt(5)
    s_add_u32 s64, s53, 15360
    buffer_load_dwordx4 v[224:227], v3, s[32:35], s64 offen offset:128 nt
    s_waitcnt vmcnt(5)
    s_add_u32 s64, s53, 15360
    buffer_load_dwordx4 v[228:231], v3, s[32:35], s64 offen offset:256 nt
    s_waitcnt vmcnt(5)
    s_add_u32 s64, s53, 18432
    buffer_load_dwordx4 v[232:235], v3, s[32:35], s64 offen offset:0 nt
    s_waitcnt vmcnt(5)
    s_add_u32 s64, s53, 18432
    buffer_load_dwordx4 v[236:239], v3, s[32:35], s64 offen offset:128 nt
    s_waitcnt vmcnt(5)
    s_add_u32 s64, s53, 18432
    buffer_load_dwordx4 v[240:243], v3, s[32:35], s64 offen offset:256 nt
    s_waitcnt vmcnt(5)
    s_add_u32 s64, s53, 21504
    buffer_load_dwordx4 v[244:247], v3, s[32:35], s64 offen offset:0 nt
    s_waitcnt vmcnt(5)
    s_add_u32 s64, s53, 21504
    buffer_load_dwordx4 v[248:251], v3, s[32:35], s64 offen offset:128 nt
    s_waitcnt vmcnt(5)
    s_add_u32 s64, s53, 21504
    buffer_load_dwordx4 v[252:255], v3, s[32:35], s64 offen offset:256 nt
    s_cmp_ge_u32 s2, 160
    s_cbranch_scc1 L_sB
    s_barrier
    v_mov_b32 v5, 0
    ds_read_b96 v[6:8], v5 offset:1536
    s_lshl_b32 s61, s3, 9
    v_add_u32 v10, s61, v22
    s_waitcnt lgkmcnt(0)
    v_readfirstlane_b32 s50, v8
    v_sub_f32 v40, v40, v6
    v_sub_f32 v41, v41, v6
    v_sub_f32 v42, v42, v6
    v_sub_f32 v43, v43, v6
    v_sub_f32 v44, v44, v6
    v_sub_f32 v45, v45, v6
    v_sub_f32 v46, v46, v6
    v_sub_f32 v47, v47, v6
    v_mul_f32 v40, 0x3fb8aa3b, v40
    v_mul_f32 v41, 0x3fb8aa3b, v41
    v_mul_f32 v42, 0x3fb8aa3b, v42
    v_mul_f32 v43, 0x3fb8aa3b, v43
    v_mul_f32 v44, 0x3fb8aa3b, v44
    v_mul_f32 v45, 0x3fb8aa3b, v45
    v_mul_f32 v46, 0x3fb8aa3b, v46
    v_mul_f32 v47, 0x3fb8aa3b, v47
    v_exp_f32 v40, v40
    v_exp_f32 v41, v41
    v_exp_f32 v42, v42
    v_exp_f32 v43, v43
    v_exp_f32 v44, v44
    v_exp_f32 v45, v45
    v_exp_f32 v46, v46
    v_exp_f32 v47, v47
    v_mul_f32 v40, v40, v7
    v_mul_f32 v41, v41, v7
    v_mul_f32 v42, v42, v7
    v_mul_f32 v43, v43, v7
    v_mul_f32 v44, v44, v7
    v_mul_f32 v45, v45, v7
    v_mul_f32 v46, v46, v7
    v_mul_f32 v47, v47, v7
    v_cvt_pk_bf16_f32 v40, v40, v40
    v_cvt_pk_bf16_f32 v41, v41, v41
    v_cvt_pk_bf16_f32 v42, v42, v42
    v_cvt_pk_bf16_f32 v43, v43, v43
    v_cvt_pk_bf16_f32 v44, v44, v44
    v_cvt_pk_bf16_f32 v45, v45, v45
    v_cvt_pk_bf16_f32 v46, v46, v46
    v_cvt_pk_bf16_f32 v47, v47, v47
    v_and_b32 v28, v40, v16
    v_and_b32 v29, v40, v17
    v_and_b32 v30, v40, v18
    v_and_b32 v31, v40, v19
    s_nop 1
    v_mfma_f32_16x16x32_bf16 v[48:51], v[28:31], v[160:163], 0
    v_mfma_f32_16x16x32_bf16 v[52:55], v[28:31], v[164:167], 0
    v_mfma_f32_16x16x32_bf16 v[56:59], v[28:31], v[168:171], 0
    v_and_b32 v32, v41, v16
    v_and_b32 v33, v41, v17
    v_and_b32 v34, v41, v18
    v_and_b32 v35, v41, v19
    s_nop 1
    v_mfma_f32_16x16x32_bf16 v[48:51], v[32:35], v[172:175], v[48:51]
    v_mfma_f32_16x16x32_bf16 v[52:55], v[32:35], v[176:179], v[52:55]
    v_mfma_f32_16x16x32_bf16 v[56:59], v[32:35], v[180:183], v[56:59]
    v_and_b32 v36, v42, v16
    v_and_b32 v37, v42, v17
    v_and_b32 v38, v42, v18
    v_and_b32 v39, v42, v19
    s_nop 1
    v_mfma_f32_16x16x32_bf16 v[48:51], v[36:39], v[184:187], v[48:51]
    v_mfma_f32_16x16x32_bf16 v[52:55], v[36:39], v[188:191], v[52:55]
    v_mfma_f32_16x16x32_bf16 v[56:59], v[36:39], v[192:195], v[56:59]
    v_and_b32 v28, v43, v16
    v_and_b32 v29, v43, v17
    v_and_b32 v30, v43, v18
    v_and_b32 v31, v43, v19
    s_nop 1
    v_mfma_f32_16x16x32_bf16 v[48:51], v[28:31], v[196:199], v[48:51]
    v_mfma_f32_16x16x32_bf16 v[52:55], v[28:31], v[200:203], v[52:55]
    v_mfma_f32_16x16x32_bf16 v[56:59], v[28:31], v[204:207], v[56:59]
    v_and_b32 v32, v44, v16
    v_and_b32 v33, v44, v17
    v_and_b32 v34, v44, v18
    v_and_b32 v35, v44, v19
    s_nop 1
    v_mfma_f32_16x16x32_bf16 v[48:51], v[32:35], v[208:211], v[48:51]
    v_mfma_f32_16x16x32_bf16 v[52:55], v[32:35], v[212:215], v[52:55]
    v_mfma_f32_16x16x32_bf16 v[56:59], v[32:35], v[216:219], v[56:59]
    v_and_b32 v36, v45, v16
    v_and_b32 v37, v45, v17
    v_and_b32 v38, v45, v18
    v_and_b32 v39, v45, v19
    s_nop 1
    v_mfma_f32_16x16x32_bf16 v[48:51], v[36:39], v[220:223], v[48:51]
    v_mfma_f32_16x16x32_bf16 v[52:55], v[36:39], v[224:227], v[52:55]
    v_mfma_f32_16x16x32_bf16 v[56:59], v[36:39], v[228:231], v[56:59]
    v_and_b32 v28, v46, v16
    v_and_b32 v29, v46, v17
    v_and_b32 v30, v46, v18
    v_and_b32 v31, v46, v19
    s_waitcnt vmcnt(5)
    buffer_load_dwordx4 v[64:67], v13, s[40:43], s56 offen nt
    v_mfma_f32_16x16x32_bf16 v[48:51], v[28:31], v[232:235], v[48:51]
    s_waitcnt vmcnt(5)
    s_add_u32 s64, s56, 10240
    buffer_load_dwordx4 v[68:71], v13, s[40:43], s64 offen nt
    v_mfma_f32_16x16x32_bf16 v[52:55], v[28:31], v[236:239], v[52:55]
    s_waitcnt vmcnt(5)
    s_add_u32 s64, s56, 20480
    buffer_load_dwordx4 v[72:75], v13, s[40:43], s64 offen nt
    v_mfma_f32_16x16x32_bf16 v[56:59], v[28:31], v[240:243], v[56:59]
    v_and_b32 v32, v47, v16
    v_and_b32 v33, v47, v17
    v_and_b32 v34, v47, v18
    v_and_b32 v35, v47, v19
    s_waitcnt vmcnt(5)
    s_add_u32 s64, s56, 30720
    buffer_load_dwordx4 v[76:79], v13, s[40:43], s64 offen nt
    v_mfma_f32_16x16x32_bf16 v[48:51], v[32:35], v[244:247], v[48:51]
    s_mov_b64 exec, s[98:99]
    s_nop 6
    ds_write_b128 v10, v[48:51] offset:16384
    s_mov_b64 exec, -1
    s_waitcnt vmcnt(5)
    s_add_u32 s64, s56, 40960
    buffer_load_dwordx4 v[80:83], v13, s[40:43], s64 offen nt
    v_mfma_f32_16x16x32_bf16 v[52:55], v[32:35], v[248:251], v[52:55]
    s_mov_b64 exec, s[98:99]
    s_nop 6
    ds_write_b128 v10, v[52:55] offset:18432
    s_mov_b64 exec, -1
    s_waitcnt vmcnt(5)
    s_add_u32 s64, s56, 51200
    buffer_load_dwordx4 v[84:87], v13, s[40:43], s64 offen nt
    v_mfma_f32_16x16x32_bf16 v[56:59], v[32:35], v[252:255], v[56:59]
    s_mov_b64 exec, s[98:99]
    s_nop 6
    ds_write_b128 v10, v[56:59] offset:20480
    s_mov_b64 exec, -1
    s_waitcnt lgkmcnt(0)
    s_barrier
    s_branch L_wo
L_sB:
    s_barrier
    v_mov_b32 v5, 0
    ds_read_b96 v[6:8], v5 offset:1536
    s_lshl_b32 s61, s3, 9
    v_add_u32 v10, s61, v22
    s_waitcnt lgkmcnt(0)
    v_readfirstlane_b32 s50, v8
    v_sub_f32 v40, v40, v6
    v_sub_f32 v41, v41, v6
    v_sub_f32 v42, v42, v6
    v_sub_f32 v43, v43, v6
    v_sub_f32 v44, v44, v6
    v_sub_f32 v45, v45, v6
    v_sub_f32 v46, v46, v6
    v_sub_f32 v47, v47, v6
    v_mul_f32 v40, 0x3fb8aa3b, v40
    v_mul_f32 v41, 0x3fb8aa3b, v41
    v_mul_f32 v42, 0x3fb8aa3b, v42
    v_mul_f32 v43, 0x3fb8aa3b, v43
    v_mul_f32 v44, 0x3fb8aa3b, v44
    v_mul_f32 v45, 0x3fb8aa3b, v45
    v_mul_f32 v46, 0x3fb8aa3b, v46
    v_mul_f32 v47, 0x3fb8aa3b, v47
    v_exp_f32 v40, v40
    v_exp_f32 v41, v41
    v_exp_f32 v42, v42
    v_exp_f32 v43, v43
    v_exp_f32 v44, v44
    v_exp_f32 v45, v45
    v_exp_f32 v46, v46
    v_exp_f32 v47, v47
    v_mul_f32 v40, v40, v7
    v_mul_f32 v41, v41, v7
    v_mul_f32 v42, v42, v7
    v_mul_f32 v43, v43, v7
    v_mul_f32 v44, v44, v7
    v_mul_f32 v45, v45, v7
    v_mul_f32 v46, v46, v7
    v_mul_f32 v47, v47, v7
    v_cvt_pk_bf16_f32 v40, v40, v40
    v_cvt_pk_bf16_f32 v41, v41, v41
    v_cvt_pk_bf16_f32 v42, v42, v42
    v_cvt_pk_bf16_f32 v43, v43, v43
    v_cvt_pk_bf16_f32 v44, v44, v44
    v_cvt_pk_bf16_f32 v45, v45, v45
    v_cvt_pk_bf16_f32 v46, v46, v46
    v_cvt_pk_bf16_f32 v47, v47, v47
    v_and_b32 v28, v40, v16
    v_and_b32 v29, v40, v17
    v_and_b32 v30, v40, v18
    v_and_b32 v31, v40, v19
    s_nop 1
    v_mfma_f32_16x16x32_bf16 v[48:51], v[28:31], v[160:163], 0
    v_mfma_f32_16x16x32_bf16 v[52:55], v[28:31], v[164:167], 0
    v_mfma_f32_16x16x32_bf16 v[56:59], v[28:31], v[168:171], 0
    v_and_b32 v32, v41, v16
    v_and_b32 v33, v41, v17
    v_and_b32 v34, v41, v18
    v_and_b32 v35, v41, v19
    s_nop 1
    v_mfma_f32_16x16x32_bf16 v[48:51], v[32:35], v[172:175], v[48:51]
    v_mfma_f32_16x16x32_bf16 v[52:55], v[32:35], v[176:179], v[52:55]
    v_mfma_f32_16x16x32_bf16 v[56:59], v[32:35], v[180:183], v[56:59]
    v_and_b32 v36, v42, v16
    v_and_b32 v37, v42, v17
    v_and_b32 v38, v42, v18
    v_and_b32 v39, v42, v19
    s_nop 1
    v_mfma_f32_16x16x32_bf16 v[48:51], v[36:39], v[184:187], v[48:51]
    v_mfma_f32_16x16x32_bf16 v[52:55], v[36:39], v[188:191], v[52:55]
    v_mfma_f32_16x16x32_bf16 v[56:59], v[36:39], v[192:195], v[56:59]
    v_and_b32 v28, v43, v16
    v_and_b32 v29, v43, v17
    v_and_b32 v30, v43, v18
    v_and_b32 v31, v43, v19
    s_nop 1
    v_mfma_f32_16x16x32_bf16 v[48:51], v[28:31], v[196:199], v[48:51]
    v_mfma_f32_16x16x32_bf16 v[52:55], v[28:31], v[200:203], v[52:55]
    v_mfma_f32_16x16x32_bf16 v[56:59], v[28:31], v[204:207], v[56:59]
    v_and_b32 v32, v44, v16
    v_and_b32 v33, v44, v17
    v_and_b32 v34, v44, v18
    v_and_b32 v35, v44, v19
    s_nop 1
    v_mfma_f32_16x16x32_bf16 v[48:51], v[32:35], v[208:211], v[48:51]
    v_mfma_f32_16x16x32_bf16 v[52:55], v[32:35], v[212:215], v[52:55]
    v_mfma_f32_16x16x32_bf16 v[56:59], v[32:35], v[216:219], v[56:59]
    v_and_b32 v36, v45, v16
    v_and_b32 v37, v45, v17
    v_and_b32 v38, v45, v18
    v_and_b32 v39, v45, v19
    s_nop 1
    v_mfma_f32_16x16x32_bf16 v[48:51], v[36:39], v[220:223], v[48:51]
    v_mfma_f32_16x16x32_bf16 v[52:55], v[36:39], v[224:227], v[52:55]
    v_mfma_f32_16x16x32_bf16 v[56:59], v[36:39], v[228:231], v[56:59]
    v_and_b32 v28, v46, v16
    v_and_b32 v29, v46, v17
    v_and_b32 v30, v46, v18
    v_and_b32 v31, v46, v19
    s_waitcnt vmcnt(5)
    s_nop 0
    v_mfma_f32_16x16x32_bf16 v[48:51], v[28:31], v[232:235], v[48:51]
    s_waitcnt vmcnt(4)
    v_mfma_f32_16x16x32_bf16 v[52:55], v[28:31], v[236:239], v[52:55]
    s_waitcnt vmcnt(3)
    v_mfma_f32_16x16x32_bf16 v[56:59], v[28:31], v[240:243], v[56:59]
    v_and_b32 v32, v47, v16
    v_and_b32 v33, v47, v17
    v_and_b32 v34, v47, v18
    v_and_b32 v35, v47, v19
    s_waitcnt vmcnt(2)
    s_nop 0
    v_mfma_f32_16x16x32_bf16 v[48:51], v[32:35], v[244:247], v[48:51]
    s_mov_b64 exec, s[98:99]
    s_nop 6
    ds_write_b128 v10, v[48:51] offset:16384
    s_mov_b64 exec, -1
    s_waitcnt vmcnt(1)
    v_mfma_f32_16x16x32_bf16 v[52:55], v[32:35], v[248:251], v[52:55]
    s_mov_b64 exec, s[98:99]
    s_nop 6
    ds_write_b128 v10, v[52:55] offset:18432
    s_mov_b64 exec, -1
    s_waitcnt vmcnt(0)
    v_mfma_f32_16x16x32_bf16 v[56:59], v[32:35], v[252:255], v[56:59]
    s_mov_b64 exec, s[98:99]
    s_nop 6
    ds_write_b128 v10, v[56:59] offset:20480
    s_mov_b64 exec, -1
    s_waitcnt lgkmcnt(0)
    s_barrier
    s_branch L_mlp
L_helper:
    s_sub_u32 s68, s3, 4
    s_cmp_eq_u32 s3, 7
    s_cbranch_scc1 L_h_noq
    s_mul_i32 s61, s68, 3072
    v_add_u32 v6, s61, v21
    s_lshl_b32 s61, s68, 8
    s_add_u32 s61, s61, s65
    v_add_u32 v5, s61, v4
    v_mul_u32_u24 v29, 5248, v2
    v_add_u32 v29, s66, v29
    ds_read_b128 v[48:51], v6 offset:5632
    ds_read_b128 v[52:55], v6 offset:6656
    ds_read_b128 v[56:59], v6 offset:7680
    s_waitcnt lgkmcnt(1)
    v_add_f32 v48, v48, v52
    v_add_f32 v49, v49, v53
    v_add_f32 v50, v50, v54
    v_add_f32 v51, v51, v55
    s_waitcnt lgkmcnt(0)
    v_add_f32 v48, v48, v56
    v_add_f32 v49, v49, v57
    v_add_f32 v50, v50, v58
    v_add_f32 v51, v51, v59
    v_permlane32_swap_b32 v48, v49
    s_nop 0
    v_permlane32_swap_b32 v50, v51
    v_add_f32 v48, v48, v49
    v_add_f32 v50, v50, v51
    s_nop 1
    v_permlane16_swap_b32 v48, v50
    v_add_f32 v48, v48, v50
    global_store_dword v5, v48, s[26:27] offset:0 sc1
    v_lshrrev_b32 v9, 2, v20
    s_lshl_b32 s60, s68, 6
    v_add_u32 v9, s60, v9
    v_mul_u32_u24 v14, 171, v9
    v_lshrrev_b32 v14, 12, v14
    v_mul_u32_u24 v5, 24, v14
    v_sub_u32 v9, v9, v5
    v_mul_u32_u24 v14, 5248, v14
    v_lshl_add_u32 v14, v9, 5, v14
    s_lshl_b32 s60, s51, 2
    s_add_u32 s60, s60, s66
    v_add_u32 v23, s60, v14
    s_mov_b32 s69, 0
L_gf:
    global_load_dwordx2 v[30:31], v29, s[26:27] offset:1664 sc1
    s_waitcnt vmcnt(0)
    v_cmp_ne_u32 vcc, s67, v30
    v_cmp_eq_u32 s[60:61], -1, v31
    s_nop 0
    s_or_b64 vcc, vcc, s[60:61]
    s_cbranch_vccz L_gf_ok
    s_add_u32 s69, s69, 1
    s_cmp_lt_u32 s69, 65536
    s_cbranch_scc1 L_gf
L_gf_ok:
    v_lshrrev_b32 v5, 4, v0
    v_mul_u32_u24 v5, 5248, v5
    v_and_b32 v6, 15, v0
    v_lshl_add_u32 v5, v6, 4, v5
    s_lshl_b32 s61, s68, 8
    s_add_u32 s61, s61, s66
    v_add_u32 v28, s61, v5
    v_add_u32 v29, 20992, v28
    global_load_dwordx4 v[48:51], v28, s[26:27] offset:0 sc1
    global_load_dwordx4 v[52:55], v29, s[26:27] offset:0 sc1
    s_mov_b32 s69, 0
L_q:
    s_waitcnt vmcnt(0)
    s_mov_b32 s64, 0
    v_max3_u32 v5, v48, v49, v50
    v_max_u32 v5, v5, v51
    v_cmp_eq_u32 vcc, -1, v5
    s_cbranch_vccz L_q_s0
    s_mov_b64 exec, vcc
    global_load_dwordx4 v[48:51], v28, s[26:27] offset:0 sc1
    s_mov_b64 exec, -1
    s_mov_b32 s64, 1
L_q_s0:
    v_max3_u32 v5, v52, v53, v54
    v_max_u32 v5, v5, v55
    v_cmp_eq_u32 vcc, -1, v5
    s_cbranch_vccz L_q_s1
    s_mov_b64 exec, vcc
    global_load_dwordx4 v[52:55], v29, s[26:27] offset:0 sc1
    s_mov_b64 exec, -1
    s_mov_b32 s64, 1
L_q_s1:
    s_cmp_eq_u32 s64, 0
    s_cbranch_scc1 L_q_ok
    s_add_u32 s69, s69, 1
    s_cmp_lt_u32 s69, 65536
    s_cbranch_scc1 L_q
    s_waitcnt vmcnt(0)
L_q_ok:
    v_add_f32 v48, v48, v52
    v_add_f32 v49, v49, v53
    v_add_f32 v50, v50, v54
    v_add_f32 v51, v51, v55
    v_permlane32_swap_b32 v48, v49
    s_nop 0
    v_permlane32_swap_b32 v50, v51
    v_add_f32 v48, v48, v49
    v_add_f32 v50, v50, v51
    s_nop 1
    v_permlane16_swap_b32 v48, v50
    v_add_f32 v48, v48, v50
    v_cvt_pk_bf16_f32 v48, v48, v48
    v_lshrrev_b32 v5, 1, v26
    s_lshl_b32 s61, s68, 7
    v_add_u32 v5, s61, v5
    ds_write_b16 v5, v48 offset:1024
    s_branch L_h_b2
L_h_noq:
    v_mul_u32_u24 v28, 173184, v2
    v_mul_u32_u24 v5, 5248, v1
    v_add_u32 v28, v28, v5
    v_add_u32 v29, 41984, v28
    v_add_u32 v30, 83968, v28
    v_add_u32 v31, 125952, v28
    s_sleep 32
    s_mov_b32 s69, 0
L_af:
    global_load_dwordx2 v[48:49], v28, s[26:27] offset:1664 sc1
    global_load_dwordx2 v[50:51], v29, s[26:27] offset:1664 sc1
    global_load_dwordx2 v[52:53], v30, s[26:27] offset:1664 sc1
    global_load_dwordx2 v[54:55], v31, s[26:27] offset:1664 sc1
    s_waitcnt vmcnt(0)
    v_xor_b32 v56, s67, v48
    v_xor_b32 v57, s67, v50
    v_xor_b32 v58, s67, v52
    v_xor_b32 v59, s67, v54
    v_or3_b32 v56, v56, v57, v58
    v_or_b32 v56, v56, v59
    v_max3_u32 v5, v49, v51, v53
    v_max_u32 v5, v5, v55
    v_cmp_ne_u32 vcc, 0, v56
    v_cmp_eq_u32 s[60:61], -1, v5
    s_nop 0
    s_or_b64 vcc, vcc, s[60:61]
    s_cbranch_vccz L_af_ok
    s_sleep 16
    s_add_u32 s69, s69, 1
    s_cmp_lt_u32 s69, 65536
    s_cbranch_scc1 L_af
L_af_ok:
    s_getreg_b32 s62, hwreg(HW_REG_XCC_ID)
    v_xor_b32 v56, s62, v49
    v_xor_b32 v57, s62, v51
    v_xor_b32 v58, s62, v53
    v_xor_b32 v59, s62, v55
    v_or3_b32 v56, v56, v57, v58
    v_or_b32 v56, v56, v59
    v_cmp_ne_u32 vcc, 0, v56
    v_cmp_eq_u32 s[60:61], s48, v2
    s_nop 0
    s_and_b64 vcc, vcc, s[60:61]
    s_cmp_eq_u64 vcc, 0
    s_cselect_b32 s50, 1, 0
L_h_b2:
    s_waitcnt lgkmcnt(0)
    s_barrier
    s_barrier
    s_cmp_lg_u32 s3, 7
    s_cbranch_scc1 L_h_noml
    v_and_b32 v5, 3, v0
    v_lshlrev_b32 v5, 3, v5
    ds_read_b64 v[8:9], v5 offset:1408
    v_mov_b32 v5, s65
    s_waitcnt lgkmcnt(0)
    v_mov_b32 v6, v8
    s_nop 1
    v_max_f32_dpp v6, v6, v6 quad_perm:[1,0,3,2] row_mask:0xf bank_mask:0xf
    s_nop 1
    v_max_f32_dpp v6, v6, v6 quad_perm:[2,3,0,1] row_mask:0xf bank_mask:0xf
    v_sub_f32 v7, v8, v6
    v_mul_f32 v7, 0x3fb8aa3b, v7
    v_exp_f32 v7, v7
    s_nop 0
    v_mul_f32 v7, v7, v9
    s_nop 1
    v_add_f32_dpp v7, v7, v7 quad_perm:[1,0,3,2] row_mask:0xf bank_mask:0xf
    s_nop 1
    v_add_f32_dpp v7, v7, v7 quad_perm:[2,3,0,1] row_mask:0xf bank_mask:0xf
    s_mov_b64 exec, 1
    global_store_dwordx2 v5, v[6:7], s[26:27] offset:1536 sc1
    s_mov_b64 exec, -1
    s_add_u32 s60, s26, s66
    s_addc_u32 s61, s27, 0
    s_mov_b32 s69, 0
L_ml:
    s_load_dwordx2 s[4:5], s[60:61], 1536 glc
    s_load_dwordx2 s[6:7], s[60:61], 6784 glc
    s_load_dwordx2 s[8:9], s[60:61], 12032 glc
    s_load_dwordx2 s[10:11], s[60:61], 17280 glc
    s_load_dwordx2 s[12:13], s[60:61], 22528 glc
    s_load_dwordx2 s[14:15], s[60:61], 27776 glc
    s_load_dwordx2 s[16:17], s[60:61], 33024 glc
    s_load_dwordx2 s[18:19], s[60:61], 38272 glc
    s_waitcnt lgkmcnt(0)
    s_max_u32 s62, s4, s5
    s_max_u32 s62, s62, s6
    s_max_u32 s62, s62, s7
    s_max_u32 s62, s62, s8
    s_max_u32 s62, s62, s9
    s_max_u32 s62, s62, s10
    s_max_u32 s62, s62, s11
    s_max_u32 s62, s62, s12
    s_max_u32 s62, s62, s13
    s_max_u32 s62, s62, s14
    s_max_u32 s62, s62, s15
    s_max_u32 s62, s62, s16
    s_max_u32 s62, s62, s17
    s_max_u32 s62, s62, s18
    s_max_u32 s62, s62, s19
    s_cmp_lg_u32 s62, -1
    s_cbranch_scc1 L_ml_ok
    s_sleep 8
    s_add_u32 s69, s69, 1
    s_cmp_lt_u32 s69, 65536
    s_cbranch_scc1 L_ml
L_ml_ok:
    v_mov_b32 v6, s4
    v_mov_b32 v7, s5
    v_writelane_b32 v6, s6, 1
    v_writelane_b32 v7, s7, 1
    v_writelane_b32 v6, s8, 2
    v_writelane_b32 v7, s9, 2
    v_writelane_b32 v6, s10, 3
    v_writelane_b32 v7, s11, 3
    v_writelane_b32 v6, s12, 4
    v_writelane_b32 v7, s13, 4
    v_writelane_b32 v6, s14, 5
    v_writelane_b32 v7, s15, 5
    v_writelane_b32 v6, s16, 6
    v_writelane_b32 v7, s17, 6
    v_writelane_b32 v6, s18, 7
    v_writelane_b32 v7, s19, 7
    v_mov_b32 v8, v6
    s_nop 1
    v_max_f32_dpp v8, v8, v8 quad_perm:[1,0,3,2] row_mask:0xf bank_mask:0xf
    s_nop 1
    v_max_f32_dpp v8, v8, v8 quad_perm:[2,3,0,1] row_mask:0xf bank_mask:0xf
    s_nop 1
    v_max_f32_dpp v8, v8, v8 row_half_mirror row_mask:0xf bank_mask:0xf
    v_sub_f32 v9, v6, v8
    v_mul_f32 v9, 0x3fb8aa3b, v9
    v_exp_f32 v9, v9
    s_nop 0
    v_mul_f32 v9, v9, v7
    s_nop 1
    v_add_f32_dpp v9, v9, v9 quad_perm:[1,0,3,2] row_mask:0xf bank_mask:0xf
    s_nop 1
    v_add_f32_dpp v9, v9, v9 quad_perm:[2,3,0,1] row_mask:0xf bank_mask:0xf
    s_nop 1
    v_add_f32_dpp v9, v9, v9 row_half_mirror row_mask:0xf bank_mask:0xf
    v_rcp_f32 v9, v9
    v_mov_b32 v10, s50
    v_mov_b32 v5, 0
    s_mov_b64 exec, 1
    ds_write_b96 v5, v[8:10] offset:1536
    s_mov_b64 exec, -1
L_h_noml:
    s_cmp_ge_u32 s2, 160
    s_cbranch_scc1 L_h_nox
    buffer_load_dwordx4 v[64:67], v13, s[40:43], s56 offen nt
    s_add_u32 s64, s56, 10240
    buffer_load_dwordx4 v[68:71], v13, s[40:43], s64 offen nt
    s_add_u32 s64, s56, 20480
    buffer_load_dwordx4 v[72:75], v13, s[40:43], s64 offen nt
    s_add_u32 s64, s56, 30720
    buffer_load_dwordx4 v[76:79], v13, s[40:43], s64 offen nt
    s_add_u32 s64, s56, 40960
    buffer_load_dwordx4 v[80:83], v13, s[40:43], s64 offen nt
    s_add_u32 s64, s56, 51200
    buffer_load_dwordx4 v[84:87], v13, s[40:43], s64 offen nt
L_h_nox:
    s_waitcnt lgkmcnt(0)
    s_barrier
    v_mov_b32 v5, 0
    ds_read_b32 v8, v5 offset:1544
    s_lshl_b32 s61, s68, 11
    v_add_u32 v6, s61, v21
    s_waitcnt lgkmcnt(0)
    v_readfirstlane_b32 s50, v8
    s_barrier
    s_cmp_eq_u32 s3, 7
    s_cbranch_scc1 L_h_noop
    ds_read_b128 v[48:51], v6 offset:16384
    ds_read_b128 v[52:55], v6 offset:17408
    s_waitcnt lgkmcnt(0)
    v_add_f32 v48, v48, v52
    v_add_f32 v49, v49, v53
    v_add_f32 v50, v50, v54
    v_add_f32 v51, v51, v55
    v_permlane32_swap_b32 v48, v49
    s_nop 0
    v_permlane32_swap_b32 v50, v51
    v_add_f32 v48, v48, v49
    v_add_f32 v50, v50, v51
    s_nop 1
    v_permlane16_swap_b32 v48, v50
    v_add_f32 v48, v48, v50
    s_cmp_eq_u32 s50, 0
    s_cbranch_scc1 L_sg0
    global_store_dword v23, v48, s[26:27] offset:768
    s_branch L_se0
L_sg0:
    global_store_dword v23, v48, s[26:27] offset:768 sc1
L_se0:
L_h_noop:
    s_cmp_ge_u32 s2, 160
    s_cbranch_scc1 L_mlp
L_wo:
    s_cmp_ge_u32 s49, 10
    s_cselect_b32 s60, 2, 0
    s_lshr_b32 s61, s3, 2
    s_add_u32 s60, s60, s61
    s_lshl_b32 s60, s60, 3
    s_and_b32 s61, s3, 3
    s_lshl_b32 s61, s61, 1
    s_add_u32 s60, s60, s61
    s_mul_i32 s60, s60, 5248
    s_mul_i32 s61, s48, 173184
    s_add_u32 s60, s60, s61
    v_add_u32 v14, s60, v4
    v_add_u32 v12, 5248, v14
    s_lshl_b32 s61, s3, 9
    v_add_u32 v11, s61, v22
    v_mov_b32 v160, -1
    v_mov_b32 v161, -1
    v_mov_b32 v162, -1
    v_mov_b32 v163, -1
    v_mov_b32 v164, -1
    v_mov_b32 v165, -1
    s_mov_b32 s69, 0
L_o:
    s_mov_b32 s64, 0
    v_max3_u32 v5, v160, v161, v162
    v_cmp_eq_u32 vcc, -1, v5
    s_cbranch_vccz L_o_s0
    s_mov_b64 exec, vcc
    global_load_dword v160, v14, s[26:27] offset:768 sc1
    global_load_dword v161, v14, s[26:27] offset:1024 sc1
    global_load_dword v162, v14, s[26:27] offset:1280 sc1
    s_mov_b64 exec, -1
    s_mov_b32 s64, 1
L_o_s0:
    v_max3_u32 v5, v163, v164, v165
    v_cmp_eq_u32 vcc, -1, v5
    s_cbranch_vccz L_o_s1
    s_mov_b64 exec, vcc
    global_load_dword v163, v12, s[26:27] offset:768 sc1
    global_load_dword v164, v12, s[26:27] offset:1024 sc1
    global_load_dword v165, v12, s[26:27] offset:1280 sc1
    s_mov_b64 exec, -1
    s_mov_b32 s64, 1
L_o_s1:
    s_cmp_eq_u32 s64, 0
    s_cbranch_scc1 L_o_ok
    s_waitcnt vmcnt(12)
    s_sleep 2
    s_add_u32 s69, s69, 1
    s_cmp_lt_u32 s69, 262144
    s_cbranch_scc1 L_o
    s_waitcnt vmcnt(0)
L_o_ok:
    v_add_f32_dpp v40, v160, v160 quad_perm:[1,0,3,2] row_mask:0xf bank_mask:0xf
    v_add_f32_dpp v41, v161, v161 quad_perm:[1,0,3,2] row_mask:0xf bank_mask:0xf
    v_add_f32_dpp v42, v162, v162 quad_perm:[1,0,3,2] row_mask:0xf bank_mask:0xf
    v_add_f32_dpp v43, v163, v163 quad_perm:[1,0,3,2] row_mask:0xf bank_mask:0xf
    v_add_f32_dpp v44, v164, v164 quad_perm:[1,0,3,2] row_mask:0xf bank_mask:0xf
    v_add_f32_dpp v45, v165, v165 quad_perm:[1,0,3,2] row_mask:0xf bank_mask:0xf
    v_add_f32_dpp v40, v40, v40 quad_perm:[2,3,0,1] row_mask:0xf bank_mask:0xf
    v_add_f32_dpp v41, v41, v41 quad_perm:[2,3,0,1] row_mask:0xf bank_mask:0xf
    v_add_f32_dpp v42, v42, v42 quad_perm:[2,3,0,1] row_mask:0xf bank_mask:0xf
    v_add_f32_dpp v43, v43, v43 quad_perm:[2,3,0,1] row_mask:0xf bank_mask:0xf
    v_add_f32_dpp v44, v44, v44 quad_perm:[2,3,0,1] row_mask:0xf bank_mask:0xf
    v_add_f32_dpp v45, v45, v45 quad_perm:[2,3,0,1] row_mask:0xf bank_mask:0xf
    v_add_f32_dpp v40, v40, v40 row_half_mirror row_mask:0xf bank_mask:0xf
    v_add_f32_dpp v41, v41, v41 row_half_mirror row_mask:0xf bank_mask:0xf
    v_add_f32_dpp v42, v42, v42 row_half_mirror row_mask:0xf bank_mask:0xf
    v_add_f32_dpp v43, v43, v43 row_half_mirror row_mask:0xf bank_mask:0xf
    v_add_f32_dpp v44, v44, v44 row_half_mirror row_mask:0xf bank_mask:0xf
    v_add_f32_dpp v45, v45, v45 row_half_mirror row_mask:0xf bank_mask:0xf
    v_cvt_pk_bf16_f32 v40, v40, v40
    v_cvt_pk_bf16_f32 v41, v41, v41
    v_cvt_pk_bf16_f32 v42, v42, v42
    v_cvt_pk_bf16_f32 v43, v43, v43
    v_cvt_pk_bf16_f32 v44, v44, v44
    v_cvt_pk_bf16_f32 v45, v45, v45
    v_and_b32 v28, v40, v16
    v_and_b32 v29, v40, v17
    v_and_b32 v30, v40, v18
    v_and_b32 v31, v40, v19
    s_nop 1
    v_mfma_f32_16x16x32_bf16 v[48:51], v[28:31], v[64:67], 0
    v_and_b32 v32, v41, v16
    v_and_b32 v33, v41, v17
    v_and_b32 v34, v41, v18
    v_and_b32 v35, v41, v19
    s_nop 1
    v_mfma_f32_16x16x32_bf16 v[48:51], v[32:35], v[68:71], v[48:51]
    v_and_b32 v36, v42, v16
    v_and_b32 v37, v42, v17
    v_and_b32 v38, v42, v18
    v_and_b32 v39, v42, v19
    s_nop 1
    v_mfma_f32_16x16x32_bf16 v[48:51], v[36:39], v[72:75], v[48:51]
    v_and_b32 v28, v43, v16
    v_and_b32 v29, v43, v17
    v_and_b32 v30, v43, v18
    v_and_b32 v31, v43, v19
    s_nop 1
    v_mfma_f32_16x16x32_bf16 v[48:51], v[28:31], v[76:79], v[48:51]
    v_and_b32 v32, v44, v16
    v_and_b32 v33, v44, v17
    v_and_b32 v34, v44, v18
    v_and_b32 v35, v44, v19
    s_nop 1
    v_mfma_f32_16x16x32_bf16 v[48:51], v[32:35], v[80:83], v[48:51]
    v_and_b32 v36, v45, v16
    v_and_b32 v37, v45, v17
    v_and_b32 v38, v45, v18
    v_and_b32 v39, v45, v19
    s_nop 1
    v_mfma_f32_16x16x32_bf16 v[48:51], v[36:39], v[84:87], v[48:51]
    s_mov_b64 exec, s[98:99]
    s_nop 6
    ds_write_b128 v11, v[48:51] offset:22528
    s_mov_b64 exec, -1
    s_waitcnt lgkmcnt(0)
    s_barrier
    s_lshl_b32 s60, s3, 8
    s_add_u32 s60, s60, s65
    v_add_u32 v5, s60, v4
    ds_read_b128 v[48:51], v21 offset:22528
    ds_read_b128 v[52:55], v21 offset:23552
    ds_read_b128 v[56:59], v21 offset:24576
    ds_read_b128 v[60:63], v21 offset:25600
    s_waitcnt lgkmcnt(2)
    v_add_f32 v48, v48, v52
    v_add_f32 v49, v49, v53
    v_add_f32 v50, v50, v54
    v_add_f32 v51, v51, v55
    s_waitcnt lgkmcnt(0)
    v_add_f32 v56, v56, v60
    v_add_f32 v57, v57, v61
    v_add_f32 v58, v58, v62
    v_add_f32 v59, v59, v63
    v_add_f32 v48, v48, v56
    v_add_f32 v49, v49, v57
    v_add_f32 v50, v50, v58
    v_add_f32 v51, v51, v59
    v_permlane32_swap_b32 v48, v49
    s_nop 0
    v_permlane32_swap_b32 v50, v51
    v_add_f32 v48, v48, v49
    v_add_f32 v50, v50, v51
    s_nop 1
    v_permlane16_swap_b32 v48, v50
    v_add_f32 v48, v48, v50
    global_store_dword v5, v48, s[26:27] offset:2048 sc1
    s_branch L_exit
L_mlp:
    s_barrier
    buffer_load_dwordx4 v[64:67], v13, s[40:43], s56 offen nt
    s_add_u32 s64, s56, 24576
    buffer_load_dwordx4 v[68:71], v13, s[40:43], s64 offen nt
    s_add_u32 s64, s56, 49152
    buffer_load_dwordx4 v[72:75], v13, s[40:43], s64 offen nt
    s_add_u32 s64, s56, 73728
    buffer_load_dwordx4 v[76:79], v13, s[40:43], s64 offen nt
    s_add_u32 s64, s56, 98304
    buffer_load_dwordx4 v[80:83], v13, s[40:43], s64 offen nt
    s_cmp_ge_u32 s3, 5
    s_cbranch_scc1 L_m_nodown
    v_mul_u32_u24 v12, 1280, v1
    v_lshl_add_u32 v12, v2, 4, v12
    s_add_u32 s64, s57, 0
    buffer_load_dwordx4 v[160:163], v12, s[44:47], s64 offen nt
    s_add_u32 s64, s57, 10240
    buffer_load_dwordx4 v[164:167], v12, s[44:47], s64 offen nt
    s_add_u32 s64, s57, 128
    buffer_load_dwordx4 v[168:171], v12, s[44:47], s64 offen nt
    s_add_u32 s64, s57, 10368
    buffer_load_dwordx4 v[172:175], v12, s[44:47], s64 offen nt
L_m_nodown:
    s_mul_i32 s61, s3, 5120
    v_add_u32 v6, s61, v21
    s_cmp_ge_u32 s3, 5
    s_cbranch_scc1 L_m_w5
    s_waitcnt vmcnt(4)
    s_branch L_m_w5d
L_m_w5:
    s_waitcnt vmcnt(0)
L_m_w5d:
    ds_write_b128 v6, v[64:67] offset:22528
    ds_write_b128 v6, v[68:71] offset:23552
    ds_write_b128 v6, v[72:75] offset:24576
    ds_write_b128 v6, v[76:79] offset:25600
    ds_write_b128 v6, v[80:83] offset:26624
    s_waitcnt lgkmcnt(0)
    s_barrier
    s_cmp_ge_u32 s3, 6
    s_cbranch_scc1 L_exit2
    s_cmp_eq_u32 s3, 5
    s_cbranch_scc1 L_fin
    v_lshrrev_b32 v5, 4, v0
    v_bfe_u32 v6, v0, 2, 2
    v_lshl_add_u32 v5, v5, 3, v6
    v_lshlrev_b32 v5, 7, v5
    v_and_b32 v6, 3, v0
    v_lshl_add_u32 v5, v6, 3, v5
    s_and_b32 s61, s3, 3
    s_lshl_b32 s61, s61, 5
    v_add_u32 v5, s61, v5
    s_sub_u32 s63, s49, 20
    s_and_b32 s63, s63, 3
    ds_read_b64_tr_b16 v[64:65], v5 offset:22528
    ds_read_b64_tr_b16 v[66:67], v5 offset:23040
    ds_read_b64_tr_b16 v[68:69], v5 offset:43008
    ds_read_b64_tr_b16 v[70:71], v5 offset:43520
    ds_read_b64_tr_b16 v[72:73], v5 offset:26624
    ds_read_b64_tr_b16 v[74:75], v5 offset:27136
    ds_read_b64_tr_b16 v[76:77], v5 offset:47104
    ds_read_b64_tr_b16 v[78:79], v5 offset:47616
    ds_read_b64_tr_b16 v[80:81], v5 offset:30720
    ds_read_b64_tr_b16 v[82:83], v5 offset:31232
    ds_read_b64_tr_b16 v[84:85], v5 offset:51200
    ds_read_b64_tr_b16 v[86:87], v5 offset:51712
    ds_read_b64_tr_b16 v[88:89], v5 offset:34816
    ds_read_b64_tr_b16 v[90:91], v5 offset:35328
    ds_read_b64_tr_b16 v[92:93], v5 offset:55296
    ds_read_b64_tr_b16 v[94:95], v5 offset:55808
    ds_read_b64_tr_b16 v[96:97], v5 offset:38912
    ds_read_b64_tr_b16 v[98:99], v5 offset:39424
    ds_read_b64_tr_b16 v[100:101], v5 offset:59392
    ds_read_b64_tr_b16 v[102:103], v5 offset:59904
    s_mul_i32 s60, s63, 640
    v_lshl_add_u32 v24, v0, 2, s60
    v_and_b32 v9, 31, v0
    v_lshl_add_u32 v9, v9, 2, s60
    s_mul_i32 s61, s3, 384
    v_lshl_add_u32 v10, v0, 1, s61
    v_lshrrev_b32 v11, 4, v0
    v_lshlrev_b32 v11, 4, v11
    v_add_u32 v11, s61, v11
    s_and_b32 s61, s3, 3
    s_sub_u32 s61, s61, s63
    s_mul_i32 s61, s61, 5248
    s_add_u32 s61, s61, s65
    s_lshl_b32 s60, s63, 4
    s_add_u32 s60, s60, s61
    s_add_u32 s60, s60, 4608
    v_bfe_u32 v6, v0, 3, 1
    v_lshlrev_b32 v6, 3, v6
    v_lshl_add_u32 v12, v2, 6, v6
    v_add_u32 v12, s60, v12
    s_lshl_b32 s60, s3, 9
    s_add_u32 s60, s60, s65
    v_lshrrev_b32 v14, 4, v0
    v_lshlrev_b32 v14, 7, v14
    v_lshl_add_u32 v14, v2, 4, v14
    v_add_u32 v14, s60, v14
    v_and_b32 v6, 3, v2
    v_lshlrev_b32 v6, 4, v6
    v_lshl_add_u32 v6, v1, 6, v6
    s_add_u32 s60, s65, 4608
    v_add_u32 v112, s60, v6
    v_lshrrev_b32 v5, 5, v0
    v_mul_u32_u24 v116, 173184, v5
    v_bfe_u32 v5, v0, 4, 1
    v_mul_u32_u24 v5, 52480, v5
    v_add_u32 v116, v116, v5
    v_and_b32 v5, 15, v0
    v_lshl_add_u32 v116, v5, 4, v116
    s_mul_i32 s60, s3, 10496
    s_lshl_b32 s61, s48, 8
    s_add_u32 s60, s60, s61
    v_add_u32 v116, s60, v116
    v_add_u32 v117, 346368, v116
    v_add_u32 v118, 692736, v116
    v_add_u32 v119, 1039104, v116
    v_add_u32 v120, 5248, v116
    v_add_u32 v121, 351616, v116
    v_add_u32 v122, 697984, v116
    v_add_u32 v123, 1044352, v116
    s_lshl_b32 s61, s3, 9
    v_add_u32 v25, s61, v26
    v_lshrrev_b32 v5, 1, v25
    v_mov_b32 v40, 0
    v_mov_b32 v41, 0
    global_load_short_d16_hi v40, v5, s[36:37]
    global_load_short_d16_hi v41, v5, s[36:37] offset:128
    v_lshlrev_b32 v4, 3, v0
    global_load_dwordx4 v[48:51], v112, s[26:27] sc1
    v_mov_b32 v176, -1
    v_mov_b32 v177, -1
    v_mov_b32 v178, -1
    v_mov_b32 v179, -1
    v_mov_b32 v180, -1
    v_mov_b32 v181, -1
    v_mov_b32 v182, -1
    v_mov_b32 v183, -1
    v_mov_b32 v184, -1
    v_mov_b32 v185, -1
    v_mov_b32 v186, -1
    v_mov_b32 v187, -1
    v_mov_b32 v188, -1
    v_mov_b32 v189, -1
    v_mov_b32 v190, -1
    v_mov_b32 v191, -1
    v_mov_b32 v192, -1
    v_mov_b32 v193, -1
    v_mov_b32 v194, -1
    v_mov_b32 v195, -1
    v_mov_b32 v196, -1
    v_mov_b32 v197, -1
    v_mov_b32 v198, -1
    v_mov_b32 v199, -1
    v_mov_b32 v200, -1
    v_mov_b32 v201, -1
    v_mov_b32 v202, -1
    v_mov_b32 v203, -1
    v_mov_b32 v204, -1
    v_mov_b32 v205, -1
    v_mov_b32 v206, -1
    v_mov_b32 v207, -1
    s_mov_b32 s69, 0
L_h:
    s_mov_b32 s64, 0
    v_max3_u32 v5, v176, v177, v178
    v_max_u32 v5, v5, v179
    v_cmp_eq_u32 vcc, -1, v5
    s_cbranch_vccz L_h_s0
    s_mov_b64 exec, vcc
    global_load_dwordx4 v[176:179], v116, s[26:27] offset:2048 sc1
    s_mov_b64 exec, -1
    s_mov_b32 s64, 1
L_h_s0:
    v_max3_u32 v5, v180, v181, v182
    v_max_u32 v5, v5, v183
    v_cmp_eq_u32 vcc, -1, v5
    s_cbranch_vccz L_h_s1
    s_mov_b64 exec, vcc
    global_load_dwordx4 v[180:183], v117, s[26:27] offset:2048 sc1
    s_mov_b64 exec, -1
    s_mov_b32 s64, 1
L_h_s1:
    v_max3_u32 v5, v184, v185, v186
    v_max_u32 v5, v5, v187
    v_cmp_eq_u32 vcc, -1, v5
    s_cbranch_vccz L_h_s2
    s_mov_b64 exec, vcc
    global_load_dwordx4 v[184:187], v118, s[26:27] offset:2048 sc1
    s_mov_b64 exec, -1
    s_mov_b32 s64, 1
L_h_s2:
    v_max3_u32 v5, v188, v189, v190
    v_max_u32 v5, v5, v191
    v_cmp_eq_u32 vcc, -1, v5
    s_cbranch_vccz L_h_s3
    s_mov_b64 exec, vcc
    global_load_dwordx4 v[188:191], v119, s[26:27] offset:2048 sc1
    s_mov_b64 exec, -1
    s_mov_b32 s64, 1
L_h_s3:
    v_max3_u32 v5, v192, v193, v194
    v_max_u32 v5, v5, v195
    v_cmp_eq_u32 vcc, -1, v5
    s_cbranch_vccz L_h_s4
    s_mov_b64 exec, vcc
    global_load_dwordx4 v[192:195], v120, s[26:27] offset:2048 sc1
    s_mov_b64 exec, -1
    s_mov_b32 s64, 1
L_h_s4:
    v_max3_u32 v5, v196, v197, v198
    v_max_u32 v5, v5, v199
    v_cmp_eq_u32 vcc, -1, v5
    s_cbranch_vccz L_h_s5
    s_mov_b64 exec, vcc
    global_load_dwordx4 v[196:199], v121, s[26:27] offset:2048 sc1
    s_mov_b64 exec, -1
    s_mov_b32 s64, 1
L_h_s5:
    v_max3_u32 v5, v200, v201, v202
    v_max_u32 v5, v5, v203
    v_cmp_eq_u32 vcc, -1, v5
    s_cbranch_vccz L_h_s6
    s_mov_b64 exec, vcc
    global_load_dwordx4 v[200:203], v122, s[26:27] offset:2048 sc1
    s_mov_b64 exec, -1
    s_mov_b32 s64, 1
L_h_s6:
    v_max3_u32 v5, v204, v205, v206
    v_max_u32 v5, v5, v207
    v_cmp_eq_u32 vcc, -1, v5
    s_cbranch_vccz L_h_s7
    s_mov_b64 exec, vcc
    global_load_dwordx4 v[204:207], v123, s[26:27] offset:2048 sc1
    s_mov_b64 exec, -1
    s_mov_b32 s64, 1
L_h_s7:
    s_cmp_eq_u32 s64, 0
    s_cbranch_scc1 L_h_ok
    s_waitcnt vmcnt(12)
    s_sleep 2
    s_add_u32 s69, s69, 1
    s_cmp_lt_u32 s69, 262144
    s_cbranch_scc1 L_h
    s_waitcnt vmcnt(0)
L_h_ok:
    v_add_f32 v208, v176, v180
    v_add_f32 v209, v177, v181
    v_add_f32 v210, v178, v182
    v_add_f32 v211, v179, v183
    v_add_f32 v212, v184, v188
    v_add_f32 v213, v185, v189
    v_add_f32 v214, v186, v190
    v_add_f32 v215, v187, v191
    v_add_f32 v208, v208, v212
    v_add_f32 v209, v209, v213
    v_add_f32 v210, v210, v214
    v_add_f32 v211, v211, v215
    v_add_f32 v224, v192, v196
    v_add_f32 v225, v193, v197
    v_add_f32 v226, v194, v198
    v_add_f32 v227, v195, v199
    v_add_f32 v228, v200, v204
    v_add_f32 v229, v201, v205
    v_add_f32 v230, v202, v206
    v_add_f32 v231, v203, v207
    v_add_f32 v224, v224, v228
    v_add_f32 v225, v225, v229
    v_add_f32 v226, v226, v230
    v_add_f32 v227, v227, v231
    v_permlane32_swap_b32 v208, v209
    v_permlane32_swap_b32 v210, v211
    v_add_f32 v208, v208, v209
    v_add_f32 v210, v210, v211
    s_nop 1
    v_permlane16_swap_b32 v208, v210
    v_add_f32 v208, v208, v210
    v_permlane32_swap_b32 v224, v225
    v_permlane32_swap_b32 v226, v227
    v_add_f32 v224, v224, v225
    v_add_f32 v226, v226, v227
    s_nop 1
    v_permlane16_swap_b32 v224, v226
    v_add_f32 v224, v224, v226
    v_cvt_pk_bf16_f32 v208, v208, v208
    v_and_b32 v208, 0xffff0000, v208
    v_cvt_pk_bf16_f32 v224, v224, v224
    v_and_b32 v224, 0xffff0000, v224
    v_add_f32 v208, v208, v40
    v_add_f32 v224, v224, v41
    v_cvt_pk_bf16_f32 v208, v208, v208
    v_and_b32 v208, 0xffff0000, v208
    v_cvt_pk_bf16_f32 v224, v224, v224
    v_and_b32 v224, 0xffff0000, v224
    ds_write_b32 v25, v208 offset:1792
    ds_write_b32 v25, v224 offset:2048
    s_waitcnt lgkmcnt(0)
    s_barrier
    s_cmp_eq_u32 s3, 4
    s_cbranch_scc1 L_m_gp
    ds_read_b128 v[48:51], v21 offset:1792
    ds_read_b128 v[52:55], v21 offset:2816
    ds_read_b64 v[56:57], v4 offset:3840
    ds_read_b32 v58, v24 offset:1792
    ds_read_b32 v59, v24 offset:2048
    ds_read_b32 v60, v9 offset:2304
    s_waitcnt lgkmcnt(0)
    v_add_f32 v7, v48, v49
    v_add_f32 v8, v50, v51
    v_add_f32 v7, v7, v52
    v_add_f32 v8, v8, v53
    v_add_f32 v7, v7, v54
    v_add_f32 v8, v8, v55
    v_add_f32 v7, v7, v56
    v_add_f32 v8, v8, v57
    v_add_f32 v7, v7, v8
    v_mov_b32 v5, 0x3acccccd
    s_nop 0
    v_add_f32_dpp v7, v7, v7 quad_perm:[1,0,3,2] row_mask:0xf bank_mask:0xf
    s_nop 1
    v_add_f32_dpp v7, v7, v7 quad_perm:[2,3,0,1] row_mask:0xf bank_mask:0xf
    s_nop 1
    v_add_f32_dpp v7, v7, v7 row_half_mirror row_mask:0xf bank_mask:0xf
    s_nop 1
    v_add_f32_dpp v7, v7, v7 row_ror:8 row_mask:0xf bank_mask:0xf
    s_nop 1
    v_add_f32_dpp v7, v7, v7 row_bcast:15 row_mask:0xa bank_mask:0xf
    s_nop 1
    v_add_f32_dpp v7, v7, v7 row_bcast:31 row_mask:0xc bank_mask:0xf
    s_nop 0
    v_readlane_b32 s64, v7, 63
    s_nop 1
    v_mul_f32 v5, s64, v5
    v_sub_f32 v48, v48, v5
    v_sub_f32 v49, v49, v5
    v_sub_f32 v50, v50, v5
    v_sub_f32 v51, v51, v5
    v_sub_f32 v52, v52, v5
    v_sub_f32 v53, v53, v5
    v_sub_f32 v54, v54, v5
    v_sub_f32 v55, v55, v5
    v_sub_f32 v56, v56, v5
    v_sub_f32 v57, v57, v5
    v_mul_f32 v7, v48, v48
    v_mul_f32 v8, v49, v49
    v_fmac_f32 v7, v50, v50
    v_fmac_f32 v8, v51, v51
    v_fmac_f32 v7, v52, v52
    v_fmac_f32 v8, v53, v53
    v_fmac_f32 v7, v54, v54
    v_fmac_f32 v8, v55, v55
    v_fmac_f32 v7, v56, v56
    v_fmac_f32 v8, v57, v57
    v_add_f32 v7, v7, v8
    v_mov_b32 v8, 0x3acccccd
    v_cvt_pk_bf16_f32 v5, v5, v5
    v_and_b32 v5, 0xffff0000, v5
    v_add_f32_dpp v7, v7, v7 quad_perm:[1,0,3,2] row_mask:0xf bank_mask:0xf
    s_nop 1
    v_add_f32_dpp v7, v7, v7 quad_perm:[2,3,0,1] row_mask:0xf bank_mask:0xf
    s_nop 1
    v_add_f32_dpp v7, v7, v7 row_half_mirror row_mask:0xf bank_mask:0xf
    s_nop 1
    v_add_f32_dpp v7, v7, v7 row_ror:8 row_mask:0xf bank_mask:0xf
    s_nop 1
    v_add_f32_dpp v7, v7, v7 row_bcast:15 row_mask:0xa bank_mask:0xf
    s_nop 1
    v_add_f32_dpp v7, v7, v7 row_bcast:31 row_mask:0xc bank_mask:0xf
    s_nop 0
    v_readlane_b32 s64, v7, 63
    s_nop 1
    v_mul_f32 v7, s64, v8
    v_cvt_pk_bf16_f32 v7, v7, v7
    v_and_b32 v7, 0xffff0000, v7
    v_add_f32 v7, 0x3727c5ac, v7
    v_cvt_pk_bf16_f32 v7, v7, v7
    v_and_b32 v7, 0xffff0000, v7
    v_sqrt_f32 v7, v7
    s_nop 0
    v_cvt_pk_bf16_f32 v7, v7, v7
    v_and_b32 v7, 0xffff0000, v7
    v_rcp_f32 v6, v7
    v_sub_f32 v58, v58, v5
    v_sub_f32 v59, v59, v5
    v_sub_f32 v60, v60, v5
    v_cvt_pk_bf16_f32 v58, v58, v58
    v_and_b32 v58, 0xffff0000, v58
    v_cvt_pk_bf16_f32 v59, v59, v59
    v_and_b32 v59, 0xffff0000, v59
    v_cvt_pk_bf16_f32 v60, v60, v60
    v_and_b32 v60, 0xffff0000, v60
    v_mul_f32 v58, v58, v6
    v_mul_f32 v59, v59, v6
    v_mul_f32 v60, v60, v6
    v_cvt_pk_bf16_f32 v58, v58, v58
    v_cvt_pk_bf16_f32 v59, v59, v59
    v_cvt_pk_bf16_f32 v60, v60, v60
    ds_write_b16 v10, v58 offset:14848
    ds_write_b16 v10, v59 offset:14976
    ds_write_b16 v10, v60 offset:15104
    ds_read_b128 v[128:131], v11 offset:14848
    ds_read_b128 v[132:135], v11 offset:14912
    ds_read_b128 v[136:139], v11 offset:14976
    ds_read_b128 v[140:143], v11 offset:15040
    ds_read_b128 v[144:147], v11 offset:15104
    s_waitcnt lgkmcnt(4)
    v_mfma_f32_16x16x32_bf16 v[48:51], v[128:131], v[64:67], 0
    v_mfma_f32_16x16x32_bf16 v[52:55], v[128:131], v[68:71], 0
    s_waitcnt lgkmcnt(3)
    v_mfma_f32_16x16x32_bf16 v[48:51], v[132:135], v[72:75], v[48:51]
    v_mfma_f32_16x16x32_bf16 v[52:55], v[132:135], v[76:79], v[52:55]
    s_waitcnt lgkmcnt(2)
    v_mfma_f32_16x16x32_bf16 v[48:51], v[136:139], v[80:83], v[48:51]
    v_mfma_f32_16x16x32_bf16 v[52:55], v[136:139], v[84:87], v[52:55]
    s_waitcnt lgkmcnt(1)
    v_mfma_f32_16x16x32_bf16 v[48:51], v[140:143], v[88:91], v[48:51]
    v_mfma_f32_16x16x32_bf16 v[52:55], v[140:143], v[92:95], v[52:55]
    s_waitcnt lgkmcnt(0)
    v_mfma_f32_16x16x32_bf16 v[48:51], v[144:147], v[96:99], v[48:51]
    v_mfma_f32_16x16x32_bf16 v[52:55], v[144:147], v[100:103], v[52:55]
    s_mov_b64 exec, 0xffff
    s_nop 6
    v_mov_b32 v49, v52
    s_cmp_eq_u32 s50, 0
    s_cbranch_scc1 L_sg1
    global_store_dwordx2 v12, v[48:49], s[26:27]
    s_branch L_se1
L_sg1:
    global_store_dwordx2 v12, v[48:49], s[26:27] sc1
L_se1:
    s_mov_b64 exec, -1
L_m_gp:
    v_mov_b32 v240, -1
    v_mov_b32 v241, -1
    v_mov_b32 v242, -1
    v_mov_b32 v243, -1
    s_mov_b32 s69, 0
L_gu:
    s_mov_b32 s64, 0
    v_max3_u32 v5, v240, v241, v242
    v_max_u32 v5, v5, v243
    v_cmp_eq_u32 vcc, -1, v5
    s_cbranch_vccz L_gu_s0
    s_mov_b64 exec, vcc
    global_load_dwordx4 v[240:243], v112, s[26:27] sc1
    s_mov_b64 exec, -1
    s_mov_b32 s64, 1
L_gu_s0:
    s_cmp_eq_u32 s64, 0
    s_cbranch_scc1 L_gu_ok
    s_waitcnt vmcnt(12)
    s_sleep 2
    s_add_u32 s69, s69, 1
    s_cmp_lt_u32 s69, 262144
    s_cbranch_scc1 L_gu
    s_waitcnt vmcnt(0)
L_gu_ok:
    v_add_f32_dpp v48, v240, v240 quad_perm:[1,0,3,2] row_mask:0xf bank_mask:0xf
    v_add_f32_dpp v50, v241, v241 quad_perm:[1,0,3,2] row_mask:0xf bank_mask:0xf
    v_add_f32_dpp v49, v242, v242 quad_perm:[1,0,3,2] row_mask:0xf bank_mask:0xf
    v_add_f32_dpp v51, v243, v243 quad_perm:[1,0,3,2] row_mask:0xf bank_mask:0xf
    v_add_f32_dpp v48, v48, v48 quad_perm:[2,3,0,1] row_mask:0xf bank_mask:0xf
    v_add_f32_dpp v50, v50, v50 quad_perm:[2,3,0,1] row_mask:0xf bank_mask:0xf
    v_add_f32_dpp v49, v49, v49 quad_perm:[2,3,0,1] row_mask:0xf bank_mask:0xf
    v_add_f32_dpp v51, v51, v51 quad_perm:[2,3,0,1] row_mask:0xf bank_mask:0xf
    v_cvt_pk_bf16_f32 v48, v48, v48
    v_and_b32 v48, 0xffff0000, v48
    v_cvt_pk_bf16_f32 v49, v49, v49
    v_and_b32 v49, 0xffff0000, v49
    v_cvt_pk_bf16_f32 v50, v50, v50
    v_and_b32 v50, 0xffff0000, v50
    v_cvt_pk_bf16_f32 v51, v51, v51
    v_and_b32 v51, 0xffff0000, v51
    v_mul_f32 v48, 0xbfb8aa3b, v48
    v_mul_f32 v49, 0xbfb8aa3b, v49
    v_exp_f32 v48, v48
    v_exp_f32 v49, v49
    v_add_f32 v48, 1.0, v48
    v_add_f32 v49, 1.0, v49
    v_rcp_f32 v48, v48
    v_rcp_f32 v49, v49
    v_cvt_pk_bf16_f32 v48, v48, v48
    v_and_b32 v48, 0xffff0000, v48
    v_cvt_pk_bf16_f32 v49, v49, v49
    v_and_b32 v49, 0xffff0000, v49
    v_mul_f32 v48, v48, v50
    v_mul_f32 v49, v49, v51
    v_cvt_pk_bf16_f32 v48, v48, v48
    v_cvt_pk_bf16_f32 v49, v49, v49
    v_and_b32 v28, v48, v16
    v_and_b32 v29, v48, v17
    v_and_b32 v30, v48, v18
    v_and_b32 v31, v48, v19
    v_and_b32 v32, v49, v16
    v_and_b32 v33, v49, v17
    v_and_b32 v34, v49, v18
    v_and_b32 v35, v49, v19
    v_mfma_f32_16x16x32_bf16 v[52:55], v[28:31], v[160:163], 0
    v_mfma_f32_16x16x32_bf16 v[56:59], v[28:31], v[168:171], 0
    v_mfma_f32_16x16x32_bf16 v[52:55], v[32:35], v[164:167], v[52:55]
    v_mfma_f32_16x16x32_bf16 v[56:59], v[32:35], v[172:175], v[56:59]
    s_mov_b32 s60, 0x00ff00ff
    s_mov_b32 s61, 0x00ff00ff
    s_nop 5
    v_permlane32_swap_b32 v52, v56
    v_permlane32_swap_b32 v53, v57
    v_permlane32_swap_b32 v54, v58
    v_permlane32_swap_b32 v55, v59
    v_add_f32_dpp v52, v56, v52 row_ror:8 row_mask:0xf bank_mask:0xf
    v_add_f32_dpp v53, v57, v53 row_ror:8 row_mask:0xf bank_mask:0xf
    v_add_f32_dpp v54, v58, v54 row_ror:8 row_mask:0xf bank_mask:0xf
    v_add_f32_dpp v55, v59, v55 row_ror:8 row_mask:0xf bank_mask:0xf
    s_mov_b64 exec, s[60:61]
    global_store_dwordx4 v14, v[52:55], s[26:27] offset:2048 sc1
    s_mov_b64 exec, -1
    s_barrier
    s_branch L_exit
L_fin:
    s_sub_u32 s60, s2, 160
    v_bfe_u32 v5, v0, 2, 3
    v_mul_u32_u24 v28, 173184, v5
    v_lshrrev_b32 v5, 5, v0
    v_mul_u32_u24 v5, 5248, v5
    v_add_u32 v28, v28, v5
    v_and_b32 v5, 3, v0
    v_lshl_add_u32 v28, v5, 4, v28
    s_min_u32 s62, s60, 39
    s_lshl_b32 s61, s62, 6
    s_add_u32 s61, s61, 104960
    v_add_u32 v28, s61, v28
    v_add_u32 v29, 10496, v28
    v_add_u32 v30, 20992, v28
    v_add_u32 v31, 31488, v28
    v_add_u32 v32, 41984, v28
    v_add_u32 v33, 52480, v28
    v_and_b32 v5, 15, v20
    v_and_b32 v6, 3, v0
    v_lshl_add_u32 v5, v6, 5, v5
    s_lshr_b32 s61, s62, 2
    s_lshl_b32 s61, s61, 8
    s_and_b32 s63, s62, 1
    s_lshl_b32 s63, s63, 7
    s_add_u32 s61, s61, s63
    s_bfe_u32 s63, s62, 0x10001
    s_lshl_b32 s63, s63, 4
    s_add_u32 s61, s61, s63
    v_add_u32 v14, s61, v5
    s_cmp_ge_u32 s2, 200
    s_cbranch_scc1 L_exit2
    s_barrier
    ds_read_b32 v10, v14 offset:1792
    v_lshrrev_b32 v14, 1, v14
    s_barrier
    v_mov_b32 v64, -1
    v_mov_b32 v65, -1
    v_mov_b32 v66, -1
    v_mov_b32 v67, -1
    v_mov_b32 v68, -1
    v_mov_b32 v69, -1
    v_mov_b32 v70, -1
    v_mov_b32 v71, -1
    v_mov_b32 v72, -1
    v_mov_b32 v73, -1
    v_mov_b32 v74, -1
    v_mov_b32 v75, -1
    v_mov_b32 v76, -1
    v_mov_b32 v77, -1
    v_mov_b32 v78, -1
    v_mov_b32 v79, -1
    v_mov_b32 v80, -1
    v_mov_b32 v81, -1
    v_mov_b32 v82, -1
    v_mov_b32 v83, -1
    v_mov_b32 v84, -1
    v_mov_b32 v85, -1
    v_mov_b32 v86, -1
    v_mov_b32 v87, -1
    s_mov_b32 s69, 0
L_d:
    s_mov_b32 s64, 0
    v_max3_u32 v5, v64, v65, v66
    v_max_u32 v5, v5, v67
    v_cmp_eq_u32 vcc, -1, v5
    s_cbranch_vccz L_d_s0
    s_mov_b64 exec, vcc
    global_load_dwordx4 v[64:67], v28, s[26:27] offset:2048 sc1
    s_mov_b64 exec, -1
    s_mov_b32 s64, 1
L_d_s0:
    v_max3_u32 v5, v68, v69, v70
    v_max_u32 v5, v5, v71
    v_cmp_eq_u32 vcc, -1, v5
    s_cbranch_vccz L_d_s1
    s_mov_b64 exec, vcc
    global_load_dwordx4 v[68:71], v29, s[26:27] offset:2048 sc1
    s_mov_b64 exec, -1
    s_mov_b32 s64, 1
L_d_s1:
    v_max3_u32 v5, v72, v73, v74
    v_max_u32 v5, v5, v75
    v_cmp_eq_u32 vcc, -1, v5
    s_cbranch_vccz L_d_s2
    s_mov_b64 exec, vcc
    global_load_dwordx4 v[72:75], v30, s[26:27] offset:2048 sc1
    s_mov_b64 exec, -1
    s_mov_b32 s64, 1
L_d_s2:
    v_max3_u32 v5, v76, v77, v78
    v_max_u32 v5, v5, v79
    v_cmp_eq_u32 vcc, -1, v5
    s_cbranch_vccz L_d_s3
    s_mov_b64 exec, vcc
    global_load_dwordx4 v[76:79], v31, s[26:27] offset:2048 sc1
    s_mov_b64 exec, -1
    s_mov_b32 s64, 1
L_d_s3:
    v_max3_u32 v5, v80, v81, v82
    v_max_u32 v5, v5, v83
    v_cmp_eq_u32 vcc, -1, v5
    s_cbranch_vccz L_d_s4
    s_mov_b64 exec, vcc
    global_load_dwordx4 v[80:83], v32, s[26:27] offset:2048 sc1
    s_mov_b64 exec, -1
    s_mov_b32 s64, 1
L_d_s4:
    v_max3_u32 v5, v84, v85, v86
    v_max_u32 v5, v5, v87
    v_cmp_eq_u32 vcc, -1, v5
    s_cbranch_vccz L_d_s5
    s_mov_b64 exec, vcc
    global_load_dwordx4 v[84:87], v33, s[26:27] offset:2048 sc1
    s_mov_b64 exec, -1
    s_mov_b32 s64, 1
L_d_s5:
    s_cmp_eq_u32 s64, 0
    s_cbranch_scc1 L_d_ok
    s_waitcnt vmcnt(12)
    s_sleep 2
    s_add_u32 s69, s69, 1
    s_cmp_lt_u32 s69, 262144
    s_cbranch_scc1 L_d
    s_waitcnt vmcnt(0)
L_d_ok:
    v_add_f32 v160, v64, v68
    v_add_f32 v161, v65, v69
    v_add_f32 v162, v66, v70
    v_add_f32 v163, v67, v71
    v_add_f32 v164, v72, v76
    v_add_f32 v165, v73, v77
    v_add_f32 v166, v74, v78
    v_add_f32 v167, v75, v79
    v_add_f32 v168, v80, v84
    v_add_f32 v169, v81, v85
    v_add_f32 v170, v82, v86
    v_add_f32 v171, v83, v87
    v_add_f32 v160, v160, v164
    v_add_f32 v161, v161, v165
    v_add_f32 v162, v162, v166
    v_add_f32 v163, v163, v167
    v_add_f32 v160, v160, v168
    v_add_f32 v161, v161, v169
    v_add_f32 v162, v162, v170
    v_add_f32 v163, v163, v171
    v_permlane32_swap_b32 v160, v161
    s_nop 0
    v_permlane32_swap_b32 v162, v163
    v_add_f32 v160, v160, v161
    v_add_f32 v162, v162, v163
    s_nop 1
    v_permlane16_swap_b32 v160, v162
    v_add_f32 v160, v160, v162
    s_nop 1
    v_add_f32_dpp v160, v160, v160 row_ror:8 row_mask:0xf bank_mask:0xf
    s_nop 1
    v_add_f32_dpp v160, v160, v160 row_ror:4 row_mask:0xf bank_mask:0xf
    v_cvt_pk_bf16_f32 v160, v160, v160
    v_and_b32 v160, 0xffff0000, v160
    s_waitcnt lgkmcnt(0)
    v_add_f32 v160, v160, v10
    v_cvt_pk_bf16_f32 v160, v160, v160
    s_mov_b32 s60, 0x000f000f
    s_mov_b32 s61, 0x000f000f
    s_mov_b64 exec, s[60:61]
    global_store_short v14, v160, s[22:23]
    s_mov_b64 exec, -1
    s_cmp_lg_u32 s2, 160
    s_cbranch_scc1 L_noep
    v_mov_b32 v6, s67
    v_mov_b32 v5, 0
    s_mov_b64 exec, 1
    global_store_dword v5, v6, s[26:27] offset:-4096 sc1
    s_mov_b64 exec, -1
L_noep:
L_exit2:
L_exit:
L_end:
    s_endpgm
.p2align 6
L_code_end:
.set CODE_BYTES, L_code_end - sequential_preLN__sliding_block_cached__glu_gated_glu__decode_kernel
.section .rodata,"a"
.p2align 6
.amdhsa_kernel sequential_preLN__sliding_block_cached__glu_gated_glu__decode_kernel
  .amdhsa_next_free_vgpr 256
  .amdhsa_next_free_sgpr 100
  .amdhsa_accum_offset 256
  .amdhsa_group_segment_fixed_size 0
  .amdhsa_kernarg_size 96
  .amdhsa_user_sgpr_count 2
  .amdhsa_user_sgpr_kernarg_segment_ptr 1
  .amdhsa_system_sgpr_workgroup_id_x 1
.end_amdhsa_kernel
```
